```python
import torch

def _softmax(x, axis=-1):
    return torch.softmax(x, dim=axis)
def _gelu(x):
    return torch.nn.functional.gelu(x, approximate="tanh")
def _silu(x):
    return torch.nn.functional.silu(x)
def _sigmoid(x):
    return torch.sigmoid(x)
def _layernorm(x, axis=-1, eps=1e-5):
    m = x.mean(dim=axis, keepdim=True)
    v = x.var(dim=axis, keepdim=True, unbiased=False)
    return (x - m) / torch.sqrt(v + eps)
def _scatter_add(tgt, idx, src, axis=0):
    return tgt.clone().index_add_(axis, idx, src)
def _segment_sum(src, seg, n):
    out = torch.zeros((n,) + src.shape[1:], dtype=src.dtype)
    return out.index_add_(0, seg, src)
def _pad(x, pw):
    flat = tuple(v for pair in reversed(pw) for v in pair)
    return torch.nn.functional.pad(x, flat)

kernel_name = 'standalone__weight_only_int_quip__prompt'

def setup_inputs():

    _w = (lambda a: (lambda t: t.to(torch.bfloat16) if t.is_floating_point() else t)(torch.as_tensor(a)))
    B, S, D, F = 1, 2048, 1024, 3584
    G = 64 if 64 > 0 else D
    D = (D // G) * G
    ng = D // G
    bits = 4 if 4 > 0 else 4
    qmax = 1 << bits
    qw = torch.randint(0, qmax, (D, F)).to(torch.int32)
    U, _ = (lambda *_a, **_k: torch.linalg.qr(*[torch.as_tensor(_x).float() for _x in _a], **_k))((lambda *s: torch.randn(*s, dtype=torch.bfloat16) * 0.05)(D, D))
    V, _ = (lambda *_a, **_k: torch.linalg.qr(*[torch.as_tensor(_x).float() for _x in _a], **_k))((lambda *s: torch.randn(*s, dtype=torch.bfloat16) * 0.05)(F, F))
    return {
        "x": _w((lambda *s: torch.randn(*s, dtype=torch.bfloat16) * 0.05)(B, S, D)),
        "qw": _w(qw),
        "scales": _w(torch.abs((lambda *s: torch.randn(*s, dtype=torch.bfloat16) * 0.05)(ng, F)) * 0.02 + 0.005),
        "zeros": _w(torch.full((ng, F), qmax / 2.0, dtype=float)),
        "U": _w(U.to(float)),
        "V": _w(V.to(float)),
    }

def reference(x, qw, scales, zeros, U, V):
    B, S, D = x.shape
    ng, F = scales.shape
    G = D // ng
    s = (lambda x, n, axis: torch.repeat_interleave(x, n, dim=axis))(scales, G, axis=0)
    z = (lambda x, n, axis: torch.repeat_interleave(x, n, dim=axis))(zeros, G, axis=0)
    wq = ((lambda x, dt: x.to(dt))(qw, x.dtype) - z) * s
    xr = torch.einsum("bsd,de->bse", x, U)
    h  = torch.einsum("bse,ef->bsf", xr, wq)
    y  = torch.einsum("bsf,fg->bsg", h, V)
    return y
```

```asm
; @launch grid=(256,1,1) block=(512,1,1) lds=149760
.amdgcn_target "amdgcn-amd-amdhsa--gfx950"
.text
.globl standalone__weight_only_int_quip__prompt_kernel
.p2align 8
.type standalone__weight_only_int_quip__prompt_kernel,@function
standalone__weight_only_int_quip__prompt_kernel:
s_cmp_ge_u32 s2, 256
s_cbranch_scc1 L_end
s_load_dwordx16 s[36:51], s[0:1], 0
s_load_dwordx2 s[30:31], s[0:1], 64
v_lshrrev_b32 v1, 6, v0
v_and_b32 v0, 63, v0
v_readfirstlane_b32 s4, v1
s_bfe_u32 s6, s2, 0x20001
s_bfe_u32 s34, s2, 0x30003
s_lshl3_add_u32 s6, s6, s34
s_and_b32 s7, s2, 1
s_lshr_b32 s34, s2, 6
s_lshl2_add_u32 s7, s7, s34
s_and_b32 s3, s4, 3
s_cmp_ge_u32 s2, 224
s_cselect_b32 s5, 1, 0
s_cbranch_scc1 L_h
L_role:
s_cmp_lt_u32 s4, 4
s_cbranch_scc1 L_c
s_lshl_b32 s34, s2, 2
s_add_u32 s15, s6, s7
s_and_b32 s15, s15, 3
v_add_u32 v88, s15, v0
v_and_b32 v89, 3, v88
v_min_u32 v89, v89, v0
v_cmp_eq_u32 vcc, 0, v89
v_or_b32 v88, 3, v88
v_subrev_u32 v88, s15, v88
v_min_u32 v88, 15, v88
v_add_u32 v89, -1, v0
v_cndmask_b32 v88, v89, v88, vcc
v_xor_b32 v88, s34, v88
v_and_b32 v88, 15, v88
s_and_b32 s34, s3, 2
s_add_u32 s34, s34, s3
s_lshl_b32 s34, s34, 6
s_add_u32 s34, s34, s7
s_lshl_b32 s34, s34, 8
v_lshl_add_u32 v13, v88, 17, s34
v_lshrrev_b32 v84, 4, v0
v_and_b32 v85, 1, v84
v_lshrrev_b32 v84, 1, v84
v_lshlrev_b32 v85, 4, v85
v_lshl_add_u32 v84, v84, 2, v85
v_and_b32 v85, 15, v0
v_lshlrev_b32 v85, 4, v85
v_mul_u32_u24 v84, 2048, v84
v_add_u32 v4, v85, v84
v_add_u32 v5, 992, v4
v_add_u32 v6, 1984, v4
v_add_u32 v7, 2976, v4
s_mul_i32 s29, s3, 4224
s_add_u32 s29, s29, 16384
v_readlane_b32 s21, v13, 0
s_mov_b32 m0, s29
s_mov_b32 s18, 2097152
s_mov_b32 s19, 0x20000
s_waitcnt lgkmcnt(0)
s_load_dword s52, s[30:31], 258048
s_mov_b64 s[16:17], s[44:45]
buffer_load_dwordx4 v4, s[16:19], s21 offen offset:0 lds
buffer_load_dwordx4 v5, s[16:19], s21 offen offset:1056 lds
buffer_load_dwordx4 v6, s[16:19], s21 offen offset:2112 lds
buffer_load_dwordx4 v7, s[16:19], s21 offen offset:3168 lds
s_lshl2_add_u32 s34, s6, s3
s_lshl_b32 s34, s34, 15
v_lshl_add_u32 v12, v88, 7, s34
s_lshl_b32 s22, s3, 11
s_mov_b32 m0, s22
v_readlane_b32 s20, v12, 0
v_readlane_b32 s21, v13, 1
v_lshrrev_b32 v84, 3, v0
v_mul_u32_u24 v84, 2048, v84
v_lshrrev_b32 v85, 4, v0
v_and_b32 v86, 7, v0
v_xor_b32 v85, v85, v86
v_lshl_add_u32 v8, v85, 4, v84
v_xor_b32 v9, 64, v8
v_add_u32 v9, 15360, v9
s_mov_b32 s8, s36
s_mov_b32 s9, s37
s_mov_b32 s10, 4194304
s_mov_b32 s11, 0x20000
buffer_load_dwordx4 v8, s[8:11], s20 offen offset:0 lds
buffer_load_dwordx4 v9, s[8:11], s20 offen offset:1024 lds
s_add_u32 m0, s29, 33280
s_mov_b32 s25, 2
s_mov_b32 s28, 33280
v_readlane_b32 s20, v12, 1
buffer_load_dwordx4 v4, s[16:19], s21 offen offset:0 lds
buffer_load_dwordx4 v5, s[16:19], s21 offen offset:1056 lds
s_and_b32 s32, s2, 1
s_bfe_u32 s33, s2, 0x20003
s_lshl2_add_u32 s32, s32, s33
s_bfe_u32 s14, s2, 0x20001
s_mul_i32 s35, s14, 7
s_lshr_b32 s34, s2, 5
s_add_u32 s33, s35, s34
s_add_u32 s35, s35, 2
s_lshr_b32 s35, s35, 2
s_add_u32 s54, s34, s35
s_add_u32 s35, s33, 2
s_lshr_b32 s35, s35, 2
s_sub_u32 s54, s54, s35
s_cmp_ge_u32 s54, 4
s_cselect_b32 s54, 16, s54
s_and_b32 s35, s33, 3
s_cmp_eq_u32 s35, 1
s_cselect_b32 s54, 16, s54
s_lshl2_add_u32 s54, s14, s54
s_add_u32 s35, s32, s33
s_and_b32 s35, s35, 3
v_add_u32 v88, s35, v0
v_and_b32 v89, 3, v88
v_min_u32 v89, v89, v0
v_cmp_eq_u32 vcc, 0, v89
v_or_b32 v88, 3, v88
v_subrev_u32 v88, s35, v88
v_min_u32 v88, 55, v88
v_add_u32 v89, -1, v0
v_cndmask_b32 v88, v89, v88, vcc
s_and_b32 s34, s32, 4
v_xor_b32 v88, s34, v88
s_mul_i32 s34, s32, 917504
s_mul_i32 s35, s3, 4096
s_add_u32 s34, s34, s35
v_mul_u32_u24 v76, 16384, v88
v_add_u32 v76, s34, v76
s_lshr_b32 s34, s3, 1
s_lshl_b32 s34, s34, 4
s_and_b32 s35, s3, 1
s_lshl_b32 s35, s35, 2
s_add_u32 s34, s34, s35
s_lshl_b32 s35, s33, 8
s_mul_i32 s34, s34, 7168
s_add_u32 s34, s34, s35
v_mul_u32_u24 v88, 458752, v88
v_add_u32 v77, s34, v88
v_lshrrev_b32 v84, 4, v0
v_and_b32 v85, 1, v84
v_lshrrev_b32 v84, 1, v84
v_lshlrev_b32 v85, 3, v85
v_lshl_add_u32 v84, v84, 5, v85
v_and_b32 v85, 15, v0
v_lshlrev_b32 v85, 4, v85
v_mul_u32_u24 v84, 7168, v84
v_add_u32 v68, v85, v84
v_add_u32 v69, 6112, v68
v_add_u32 v70, 12224, v68
v_add_u32 v71, 18336, v68
v_lshrrev_b32 v84, 3, v0
v_mul_u32_u24 v84, 128, v84
v_lshrrev_b32 v85, 4, v0
v_and_b32 v86, 7, v0
v_xor_b32 v85, v85, v86
v_lshl_add_u32 v72, v85, 4, v84
v_xor_b32 v73, 64, v72
v_add_u32 v74, 0, v72
v_add_u32 v75, 0, v73
v_add_u32 v73, 0, v73
s_mov_b32 s24, 3
v_lshrrev_b32 v88, 1, v0
v_add_u32 v89, s24, v88
v_xor_b32 v89, s32, v89
v_and_b32 v89, 4, v89
v_add_u32 v88, s32, v88
v_and_or_b32 v88, v88, 3, v89
v_and_b32 v89, 1, v0
v_lshl_add_u32 v88, v88, 1, v89
s_lshl_b32 s34, s32, 19
s_lshl_b32 s35, s3, 13
s_add_u32 s34, s34, s35
v_lshl_add_u32 v93, v88, 15, s34
s_lshr_b32 s34, s3, 1
s_mul_i32 s34, s34, 229376
s_and_b32 s35, s3, 1
s_lshl_b32 s14, s33, 1
s_add_u32 s35, s35, s14
s_lshl_b32 s35, s35, 12
s_add_u32 s34, s34, s35
v_mul_u32_u24 v88, 458752, v88
v_add_u32 v94, s34, v88
s_add_u32 s40, s30, 13631488
s_addc_u32 s41, s31, 0
s_mov_b32 s42, 4194304
s_mov_b32 s43, 0x20000
s_add_u32 s48, s30, 20971456
s_addc_u32 s49, s31, 0
s_mov_b32 s50, 7340096
s_mov_b32 s51, 0x20000
v_lshlrev_b32 v82, 4, v0
v_lshlrev_b32 v83, 8, v0
v_add_u32 v78, 64, v82
v_add_u32 v79, 48, v82
v_add_u32 v80, 32, v82
v_add_u32 v81, 16, v82
s_lshl_b32 s26, s32, 12
s_add_u32 s26, s26, 262144
s_lshl_b32 s27, s54, 8
s_add_u32 s27, s27, s26
s_mov_b32 s56, s30
s_mov_b32 s57, s31
s_mov_b32 s58, 294912
s_mov_b32 s59, 0x20000
s_waitcnt lgkmcnt(0)
s_mul_i32 s52, s52, 1664525
s_add_u32 s52, s52, 1013904223
s_cmp_lt_u32 s54, 16
s_cselect_b32 s54, 7, 255
s_cmp_eq_u32 s3, 1
s_cselect_b32 s54, s54, 255
s_cselect_b32 s55, 2, 0
s_or_b32 s14, s3, s5
s_cmp_eq_u32 s14, 0
s_cselect_b32 s54, 13, s54
s_branch Lxl_go2
Lxl_loop:
buffer_load_dwordx4 v9, s[8:11], s20 offen offset:1024 lds
s_mov_b32 m0, s34
s_cmp_lt_u32 s25, 3
s_cbranch_scc1 Lxl_go
s_waitcnt vmcnt(12)
s_barrier
Lxl_go:
buffer_load_dwordx4 v4, s[16:19], s21 offen offset:0 lds
v_readlane_b32 s20, v12, s25
s_add_u32 s25, s25, 1
s_cmp_eq_u32 s25, s54
s_cbranch_scc1 Lxl_ev
Lxl_evdone:
buffer_load_dwordx4 v5, s[16:19], s21 offen offset:1056 lds
Lxl_go2:
s_add_u32 s34, s28, s22
s_add_u32 s28, s28, 33280
buffer_load_dwordx4 v6, s[16:19], s21 offen offset:2112 lds
s_cmp_eq_u32 s28, 133120
s_cselect_b32 s28, 0, s28
buffer_load_dwordx4 v7, s[16:19], s21 offen offset:3168 lds
s_mov_b32 m0, s34
v_readlane_b32 s21, v13, s25
s_add_u32 s34, s28, s29
s_cmp_lt_u32 s25, 16
buffer_load_dwordx4 v8, s[8:11], s20 offen offset:0 lds
s_cbranch_scc1 Lxl_loop
buffer_load_dwordx4 v9, s[8:11], s20 offen offset:1024 lds
s_cmp_lg_u32 s5, 0
s_cbranch_scc1 Ll_h
s_add_u32 s8, s30, 1048576
s_addc_u32 s9, s31, 0
s_mov_b32 s10, 11010048
s_mov_b32 s11, 0x20000
s_mov_b32 s16, s46
s_mov_b32 s17, s47
s_mov_b32 s18, 25690112
s_mov_b32 s19, 0x20000
s_lshl_b32 s22, s3, 12
v_readlane_b32 s21, v77, 0
v_readlane_b32 s20, v76, 0
s_mov_b32 m0, s29
s_mul_i32 s26, s32, 14336
s_add_u32 s26, s26, 1024
s_mov_b32 s14, 8
s_cmp_eq_u32 s3, 0
s_cselect_b32 s54, 4, 255
s_cmp_eq_u32 s3, 1
s_cselect_b32 s54, s14, s54
s_mov_b32 s55, 0
s_waitcnt vmcnt(12)
s_barrier
buffer_load_dwordx4 v68, s[16:19], s21 offen offset:0 lds
buffer_load_dwordx4 v69, s[16:19], s21 offen offset:1056 lds
buffer_load_dwordx4 v70, s[16:19], s21 offen offset:2112 lds
buffer_load_dwordx4 v71, s[16:19], s21 offen offset:3168 lds
s_mov_b32 m0, s22
v_readlane_b32 s21, v77, 1
buffer_load_dwordx4 v72, s[8:11], s20 offen offset:0 sc1 lds
buffer_load_dwordx4 v73, s[8:11], s20 offen offset:1024 sc1 lds
buffer_load_dwordx4 v74, s[8:11], s20 offen offset:2048 sc1 lds
buffer_load_dwordx4 v75, s[8:11], s20 offen offset:3072 sc1 lds
s_add_u32 m0, s29, 33280
s_mov_b32 s25, 1
s_mov_b32 s28, 33280
s_waitcnt vmcnt(14)
s_barrier
s_branch Lw_go
Lw_loop:
buffer_load_dwordx4 v75, s[8:11], s20 offen offset:3072 sc1 lds
s_add_u32 m0, s28, s29
s_waitcnt vmcnt(16)
s_barrier
Lw_go:
buffer_load_dwordx4 v68, s[16:19], s21 offen offset:0 lds
v_readlane_b32 s20, v76, s25
s_add_u32 s25, s25, 1
s_cmp_eq_u32 s25, s54
s_cbranch_scc1 Lw_ev
Lw_evdone:
buffer_load_dwordx4 v69, s[16:19], s21 offen offset:1056 lds
s_add_u32 s34, s28, s22
s_add_u32 s28, s28, 33280
buffer_load_dwordx4 v70, s[16:19], s21 offen offset:2112 lds
s_cmp_eq_u32 s28, 133120
s_cselect_b32 s28, 0, s28
buffer_load_dwordx4 v71, s[16:19], s21 offen offset:3168 lds
s_mov_b32 m0, s34
v_readlane_b32 s21, v77, s25
buffer_load_dwordx4 v72, s[8:11], s20 offen offset:0 sc1 lds
buffer_load_dwordx4 v73, s[8:11], s20 offen offset:1024 sc1 lds
s_cmp_lt_u32 s25, 56
buffer_load_dwordx4 v74, s[8:11], s20 offen offset:2048 sc1 lds
s_cbranch_scc1 Lw_loop
buffer_load_dwordx4 v75, s[8:11], s20 offen offset:3072 sc1 lds
s_lshl_b32 s22, s3, 13
s_mul_i32 s29, s3, 4160
s_add_u32 s29, s29, 99840
s_waitcnt vmcnt(16)
s_barrier
v_readlane_b32 s20, v93, 0
s_add_u32 m0, s22, 0
s_nop 3
buffer_load_dwordx4 v82, s[40:43], s20 offen offset:0 sc1 lds
buffer_load_dwordx4 v82, s[40:43], s20 offen offset:1024 sc1 lds
buffer_load_dwordx4 v82, s[40:43], s20 offen offset:2048 sc1 lds
buffer_load_dwordx4 v82, s[40:43], s20 offen offset:3072 sc1 lds
s_add_u32 m0, m0, 4096
s_add_u32 s20, s20, 4096
buffer_load_dwordx4 v82, s[40:43], s20 offen offset:0 sc1 lds
buffer_load_dwordx4 v82, s[40:43], s20 offen offset:1024 sc1 lds
buffer_load_dwordx4 v82, s[40:43], s20 offen offset:2048 sc1 lds
buffer_load_dwordx4 v82, s[40:43], s20 offen offset:3072 sc1 lds
s_waitcnt vmcnt(16)
s_barrier
v_readlane_b32 s20, v93, 1
s_add_u32 m0, s22, 33280
s_nop 3
buffer_load_dwordx4 v82, s[40:43], s20 offen offset:0 sc1 lds
buffer_load_dwordx4 v82, s[40:43], s20 offen offset:1024 sc1 lds
buffer_load_dwordx4 v82, s[40:43], s20 offen offset:2048 sc1 lds
buffer_load_dwordx4 v82, s[40:43], s20 offen offset:3072 sc1 lds
s_add_u32 m0, m0, 4096
s_add_u32 s20, s20, 4096
buffer_load_dwordx4 v82, s[40:43], s20 offen offset:0 sc1 lds
buffer_load_dwordx4 v82, s[40:43], s20 offen offset:1024 sc1 lds
buffer_load_dwordx4 v82, s[40:43], s20 offen offset:2048 sc1 lds
buffer_load_dwordx4 v82, s[40:43], s20 offen offset:3072 sc1 lds
s_waitcnt vmcnt(16)
s_barrier
v_readlane_b32 s20, v93, 2
s_add_u32 m0, s22, 66560
s_nop 3
buffer_load_dwordx4 v82, s[40:43], s20 offen offset:0 sc1 lds
buffer_load_dwordx4 v82, s[40:43], s20 offen offset:1024 sc1 lds
buffer_load_dwordx4 v82, s[40:43], s20 offen offset:2048 sc1 lds
buffer_load_dwordx4 v82, s[40:43], s20 offen offset:3072 sc1 lds
s_add_u32 m0, m0, 4096
s_add_u32 s20, s20, 4096
buffer_load_dwordx4 v82, s[40:43], s20 offen offset:0 sc1 lds
buffer_load_dwordx4 v82, s[40:43], s20 offen offset:1024 sc1 lds
buffer_load_dwordx4 v82, s[40:43], s20 offen offset:2048 sc1 lds
buffer_load_dwordx4 v82, s[40:43], s20 offen offset:3072 sc1 lds
s_barrier
s_lshl_b32 s26, s33, 3
s_add_u32 s26, s26, s32
s_lshl_b32 s27, s26, 8
s_add_u32 s27, s27, 196608
s_andn2_b32 s26, s27, 0x300
s_and_b32 s14, s24, 1
s_lshl_b32 s14, s14, 10
s_xor_b32 s26, s26, s14
s_waitcnt vmcnt(16)
s_barrier
s_add_u32 s12, s30, s26
s_addc_u32 s13, s31, 0
s_load_dword s98, s[12:13], 0
s_load_dword s99, s[12:13], 256
s_load_dword s100, s[12:13], 512
s_load_dword s101, s[12:13], 768
s_cmp_lg_u32 s3, 0
s_waitcnt vmcnt(8)
s_barrier
s_cbranch_scc1 Lw_nfb
v_mov_b32 v84, s52
v_mov_b32 v85, s52
v_mov_b32 v86, s52
v_mov_b32 v87, s52
s_mov_b64 exec, 0xff
buffer_store_dwordx4 v[84:87], v82, s[56:59], s27 offen sc1
s_mov_b64 exec, -1
Lw_nfb:
s_mov_b32 s25, 5
s_mov_b32 s28, 66560
s_mov_b32 s27, 33280
s_and_b32 s14, s24, 2
s_add_u32 s14, s14, 7
s_cmp_eq_u32 s3, 0
s_cselect_b32 s54, s14, 255
s_waitcnt lgkmcnt(0)
s_xor_b32 s14, s98, s52
s_xor_b32 s15, s99, s52
s_or_b32 s14, s14, s15
s_xor_b32 s15, s100, s52
s_or_b32 s14, s14, s15
s_xor_b32 s15, s101, s52
s_or_b32 s14, s14, s15
s_cbranch_scc0 Lw_pb_x
s_mov_b32 s53, 262144
Lw_pb:
s_mov_b64 exec, 0xf
buffer_load_dword v92, v83, s[56:59], s26 offen sc1
s_mov_b64 exec, -1
s_sub_u32 s53, s53, 1
s_cmp_eq_u32 s53, 0
s_cbranch_scc1 Lw_pb_x
s_waitcnt vmcnt(0)
Lw_pb_c:
v_cmp_ne_u32 vcc, s52, v92
s_and_b32 vcc_lo, vcc_lo, 0xf
s_cbranch_scc1 Lw_pb
Lw_pb_x:
s_xor_b32 s26, s26, 0x400
v_readlane_b32 s21, v94, 2
s_add_u32 m0, s29, 33280
s_nop 3
buffer_load_dwordx4 v78, s[48:51], s21 offen offset:0 sc1 lds
buffer_load_dwordx4 v79, s[48:51], s21 offen offset:1040 sc1 lds
buffer_load_dwordx4 v80, s[48:51], s21 offen offset:2080 sc1 lds
buffer_load_dwordx4 v81, s[48:51], s21 offen offset:3120 sc1 lds
v_readlane_b32 s21, v94, 3
s_add_u32 m0, s29, 0
s_nop 3
buffer_load_dwordx4 v78, s[48:51], s21 offen offset:0 sc1 lds
buffer_load_dwordx4 v79, s[48:51], s21 offen offset:1040 sc1 lds
buffer_load_dwordx4 v80, s[48:51], s21 offen offset:2080 sc1 lds
buffer_load_dwordx4 v81, s[48:51], s21 offen offset:3120 sc1 lds
v_readlane_b32 s20, v93, 3
s_add_u32 m0, s22, 0
s_nop 3
buffer_load_dwordx4 v82, s[40:43], s20 offen offset:0 sc1 lds
buffer_load_dwordx4 v82, s[40:43], s20 offen offset:1024 sc1 lds
buffer_load_dwordx4 v82, s[40:43], s20 offen offset:2048 sc1 lds
buffer_load_dwordx4 v82, s[40:43], s20 offen offset:3072 sc1 lds
s_add_u32 m0, m0, 4096
s_add_u32 s20, s20, 4096
buffer_load_dwordx4 v82, s[40:43], s20 offen offset:0 sc1 lds
buffer_load_dwordx4 v82, s[40:43], s20 offen offset:1024 sc1 lds
buffer_load_dwordx4 v82, s[40:43], s20 offen offset:2048 sc1 lds
buffer_load_dwordx4 v82, s[40:43], s20 offen offset:3072 sc1 lds
s_waitcnt vmcnt(12)
s_barrier
v_readlane_b32 s21, v94, 4
s_add_u32 m0, s29, 16640
s_nop 3
buffer_load_dwordx4 v78, s[48:51], s21 offen offset:0 sc1 lds
buffer_load_dwordx4 v79, s[48:51], s21 offen offset:1040 sc1 lds
buffer_load_dwordx4 v80, s[48:51], s21 offen offset:2080 sc1 lds
buffer_load_dwordx4 v81, s[48:51], s21 offen offset:3120 sc1 lds
v_readlane_b32 s20, v93, 4
s_add_u32 m0, s22, 33280
s_nop 3
buffer_load_dwordx4 v82, s[40:43], s20 offen offset:0 sc1 lds
buffer_load_dwordx4 v82, s[40:43], s20 offen offset:1024 sc1 lds
buffer_load_dwordx4 v82, s[40:43], s20 offen offset:2048 sc1 lds
buffer_load_dwordx4 v82, s[40:43], s20 offen offset:3072 sc1 lds
s_add_u32 m0, m0, 4096
s_add_u32 s20, s20, 4096
s_waitcnt vmcnt(8)
s_barrier
buffer_load_dwordx4 v82, s[40:43], s20 offen offset:0 sc1 lds
buffer_load_dwordx4 v82, s[40:43], s20 offen offset:1024 sc1 lds
buffer_load_dwordx4 v82, s[40:43], s20 offen offset:2048 sc1 lds
buffer_load_dwordx4 v82, s[40:43], s20 offen offset:3072 sc1 lds
Lw_cloop:
s_cmp_lg_u32 s25, s54
s_cbranch_scc1 Lw_c3
s_add_u32 s12, s30, s26
s_addc_u32 s13, s31, 0
s_load_dword s98, s[12:13], 0
s_load_dword s99, s[12:13], 256
s_load_dword s100, s[12:13], 512
s_load_dword s101, s[12:13], 768
Lw_c3:
v_readlane_b32 s21, v94, s25
s_add_u32 m0, s29, s27
s_nop 3
buffer_load_dwordx4 v78, s[48:51], s21 offen offset:0 sc1 lds
buffer_load_dwordx4 v79, s[48:51], s21 offen offset:1040 sc1 lds
buffer_load_dwordx4 v80, s[48:51], s21 offen offset:2080 sc1 lds
buffer_load_dwordx4 v81, s[48:51], s21 offen offset:3120 sc1 lds
v_readlane_b32 s20, v93, s25
s_add_u32 m0, s22, s28
s_nop 3
buffer_load_dwordx4 v82, s[40:43], s20 offen offset:0 sc1 lds
buffer_load_dwordx4 v82, s[40:43], s20 offen offset:1024 sc1 lds
buffer_load_dwordx4 v82, s[40:43], s20 offen offset:2048 sc1 lds
buffer_load_dwordx4 v82, s[40:43], s20 offen offset:3072 sc1 lds
s_add_u32 m0, m0, 4096
s_add_u32 s20, s20, 4096
buffer_load_dwordx4 v82, s[40:43], s20 offen offset:0 sc1 lds
buffer_load_dwordx4 v82, s[40:43], s20 offen offset:1024 sc1 lds
buffer_load_dwordx4 v82, s[40:43], s20 offen offset:2048 sc1 lds
buffer_load_dwordx4 v82, s[40:43], s20 offen offset:3072 sc1 lds
s_add_u32 s27, s27, 16640
s_add_u32 s28, s28, 33280
s_cmp_eq_u32 s28, 99840
s_cselect_b32 s28, 0, s28
s_cselect_b32 s27, 0, s27
s_cmp_lg_u32 s25, s54
s_cbranch_scc1 Lw_pc_x
s_waitcnt lgkmcnt(0)
s_xor_b32 s14, s98, s52
s_xor_b32 s15, s99, s52
s_or_b32 s14, s14, s15
s_xor_b32 s15, s100, s52
s_or_b32 s14, s14, s15
s_xor_b32 s15, s101, s52
s_or_b32 s14, s14, s15
s_cbranch_scc0 Lw_pc_x
s_mov_b32 s53, 262144
Lw_pc:
s_mov_b64 exec, 0xf
buffer_load_dword v92, v83, s[56:59], s26 offen sc1
s_mov_b64 exec, -1
s_sub_u32 s53, s53, 1
s_cmp_eq_u32 s53, 0
s_cbranch_scc1 Lw_pc_x
s_waitcnt vmcnt(0)
Lw_pc_c:
v_cmp_ne_u32 vcc, s52, v92
s_and_b32 vcc_lo, vcc_lo, 0xf
s_cbranch_scc1 Lw_pc
Lw_pc_x:
s_add_u32 s25, s25, 1
s_cmp_lt_u32 s25, 16
s_waitcnt vmcnt(12)
s_barrier
s_cbranch_scc1 Lw_cloop
s_waitcnt vmcnt(0)
s_barrier
s_endpgm
Lw_ev:
s_cmp_lg_u32 s3, 0
s_cbranch_scc1 Lw_evx
s_bitcmp1_b32 s25, 0
s_cbranch_scc1 Lw_evc
s_add_u32 s26, s26, 2048
s_add_u32 s54, s54, 1
s_add_u32 s12, s30, s26
s_addc_u32 s13, s31, 0
s_load_dword s98, s[12:13], 0
s_load_dword s99, s[12:13], 256
s_load_dword s100, s[12:13], 512
s_load_dword s101, s[12:13], 768
s_branch Lw_evdone
Lw_evc:
s_waitcnt lgkmcnt(0)
s_xor_b32 s14, s98, s52
s_xor_b32 s15, s99, s52
s_or_b32 s14, s14, s15
s_xor_b32 s15, s100, s52
s_or_b32 s14, s14, s15
s_xor_b32 s15, s101, s52
s_or_b32 s14, s14, s15
s_cbranch_scc0 Lw_pa_x
s_mov_b32 s53, 262144
Lw_pa:
s_mov_b64 exec, 0xf
buffer_load_dword v92, v83, s[56:59], s26 offen sc1
s_mov_b64 exec, -1
s_sub_u32 s53, s53, 1
s_cmp_eq_u32 s53, 0
s_cbranch_scc1 Lw_pa_x
s_waitcnt vmcnt(0)
Lw_pa_c:
v_cmp_ne_u32 vcc, s52, v92
s_and_b32 vcc_lo, vcc_lo, 0xf
s_cbranch_scc1 Lw_pa
Lw_pa_x:
s_add_u32 s54, s54, 7
s_cmp_gt_u32 s54, 48
s_cselect_b32 s54, 255, s54
s_branch Lw_evdone
Lw_evx:
s_cmp_lg_u32 s55, 0
s_cbranch_scc1 Lw_evx1
s_mov_b32 s55, 1
s_lshl_b32 s27, s6, 3
s_add_u32 s27, s27, s7
s_lshl_b32 s27, s27, 8
s_add_u32 s27, s27, 131072
v_mov_b32 v84, s52
v_mov_b32 v85, s52
v_mov_b32 v86, s52
v_mov_b32 v87, s52
s_mov_b64 exec, 0xff
buffer_store_dwordx4 v[84:87], v82, s[56:59], s27 offen sc1
s_mov_b64 exec, -1
s_mov_b32 s54, 52
s_branch Lw_evdone
Lw_evx1:
s_cmp_lg_u32 s55, 1
s_cbranch_scc1 Lw_evx2
s_mov_b32 s55, 2
s_lshl_b32 s26, s32, 13
s_add_u32 s26, s26, 131072
s_mov_b32 s54, 55
s_mov_b64 exec, 0xffffffff
buffer_load_dword v92, v83, s[56:59], s26 offen sc1
s_mov_b64 exec, -1
s_branch Lw_evdone
Lw_evx2:
s_mov_b32 s55, 3
s_mov_b32 s53, 262144
s_branch Lw_px_c
Lw_px:
s_mov_b64 exec, 0xffffffff
buffer_load_dword v92, v83, s[56:59], s26 offen sc1
s_mov_b64 exec, -1
s_sub_u32 s53, s53, 1
s_cmp_eq_u32 s53, 0
s_cbranch_scc1 Lw_px_x
s_waitcnt vmcnt(0)
Lw_px_c:
v_cmp_ne_u32 vcc, s52, v92
s_and_b32 vcc_lo, vcc_lo, 0xffffffff
s_cbranch_scc1 Lw_px
Lw_px_x:
s_mov_b32 s54, 255
s_branch Lw_evdone
Lxl_ev:
s_cmp_lg_u32 s55, 0
s_cbranch_scc1 Lxl_ev1
s_mov_b32 s55, 1
s_mov_b64 exec, 0xffff
buffer_load_dword v92, v83, s[56:59], s26 offen sc1
s_mov_b64 exec, -1
s_mov_b32 s54, 16
s_branch Lxl_evdone
Lxl_ev1:
s_cmp_lg_u32 s55, 1
s_cbranch_scc1 Lxl_ev2
s_mov_b32 s55, 2
s_mov_b32 s53, 262144
s_branch Lw_pa0_c
Lw_pa0:
s_mov_b64 exec, 0xffff
buffer_load_dword v92, v83, s[56:59], s26 offen sc1
s_mov_b64 exec, -1
s_sub_u32 s53, s53, 1
s_cmp_eq_u32 s53, 0
s_cbranch_scc1 Lw_pa0_x
s_waitcnt vmcnt(0)
Lw_pa0_c:
v_cmp_ne_u32 vcc, s52, v92
s_and_b32 vcc_lo, vcc_lo, 0xffff
s_cbranch_scc1 Lw_pa0
Lw_pa0_x:
s_mov_b32 s54, 255
s_branch Lxl_evdone
Lxl_ev2:
s_mov_b32 s55, 3
v_mov_b32 v84, s52
v_mov_b32 v85, s52
v_mov_b32 v86, s52
v_mov_b32 v87, s52
s_mov_b64 exec, 0xff
buffer_store_dwordx4 v[84:87], v82, s[56:59], s27 offen sc1
s_mov_b64 exec, -1
s_mov_b32 s54, 255
s_branch Lxl_evdone
Ll_h:
s_waitcnt vmcnt(12)
s_barrier
s_waitcnt vmcnt(6)
s_barrier
s_waitcnt vmcnt(0)
s_barrier
s_endpgm
L_h:
s_and_b32 s32, s2, 7
s_bfe_u32 s33, s2, 0x20003
s_lshl_b32 s14, s32, 3
s_add_u32 s14, s14, s4
s_mul_i32 s34, s14, 229376
v_lshrrev_b32 v1, 3, v0
v_and_b32 v2, 7, v0
v_mul_u32_u24 v1, 14336, v1
v_lshl_add_u32 v1, v2, 4, v1
v_add_u32 v132, s34, v1
v_add_u32 v133, 114688, v132
s_lshr_b32 s34, s4, 2
s_mul_i32 s34, s34, 7168
v_lshl_add_u32 v134, v2, 3, s34
v_lshlrev_b32 v135, 4, v0
v_mov_b32 v140, 0
v_mov_b32 v141, 0
v_add_u32 v140, v140, v135
v_add_u32 v141, v141, v135
s_mul_i32 s24, s32, 917504
s_mul_i32 s34, s4, 2048
s_add_u32 s24, s24, s34
s_mov_b32 s23, 2
s_min_u32 s14, s4, 6
s_lshl_b32 s26, s14, 11
s_mul_i32 s35, s32, 14336
s_add_u32 s35, s35, s26
s_mov_b32 m0, s26
s_waitcnt lgkmcnt(0)
s_load_dword s52, s[30:31], 258048
s_mov_b32 s8, s40
s_mov_b32 s9, s41
s_mov_b32 s10, 114688
s_mov_b32 s11, 0x20000
buffer_load_dwordx4 v135, s[8:11], s35 offen offset:0 lds
buffer_load_dwordx4 v135, s[8:11], s35 offen offset:1024 lds
s_add_u32 m0, s26, 14336
s_mov_b32 s8, s42
s_mov_b32 s9, s43
s_mov_b32 s10, 114688
s_mov_b32 s11, 0x20000
buffer_load_dwordx4 v135, s[8:11], s35 offen offset:0 lds
buffer_load_dwordx4 v135, s[8:11], s35 offen offset:1024 lds
s_mov_b32 s16, s38
s_mov_b32 s17, s39
s_mov_b32 s18, 14680064
s_mov_b32 s19, 0x20000
s_add_u32 s15, s33, s23
s_and_b32 s15, s15, 3
s_lshl_b32 s14, s23, 2
s_add_u32 s15, s15, s14
s_add_u32 s23, s23, 1
s_and_b32 s14, s32, 4
s_xor_b32 s15, s15, s14
s_lshl_b32 s25, s15, 8
s_cmp_ge_u32 s15, 56
s_cselect_b32 s14, 0x40000000, 0
v_or_b32 v132, s14, v132
v_or_b32 v133, s14, v133
s_mul_i32 s14, s15, 16384
s_add_u32 s20, s24, s14
s_lshl_b32 s14, s15, 7
v_add_u32 v9, s14, v134
buffer_load_dwordx4 v[36:39], v132, s[16:19], s25 offen offset:0 nt
buffer_load_dwordx4 v[40:43], v132, s[16:19], s25 offen offset:128 nt
buffer_load_dwordx4 v[44:47], v133, s[16:19], s25 offen offset:0 nt
buffer_load_dwordx4 v[48:51], v133, s[16:19], s25 offen offset:128 nt
s_add_u32 s15, s33, s23
s_and_b32 s15, s15, 3
s_lshl_b32 s14, s23, 2
s_add_u32 s15, s15, s14
s_add_u32 s23, s23, 1
s_and_b32 s14, s32, 4
s_xor_b32 s15, s15, s14
s_lshl_b32 s25, s15, 8
s_mul_i32 s14, s15, 16384
s_add_u32 s21, s24, s14
s_lshl_b32 s14, s15, 7
v_add_u32 v73, s14, v134
buffer_load_dwordx4 v[100:103], v132, s[16:19], s25 offen offset:0 nt
buffer_load_dwordx4 v[104:107], v132, s[16:19], s25 offen offset:128 nt
buffer_load_dwordx4 v[108:111], v133, s[16:19], s25 offen offset:0 nt
buffer_load_dwordx4 v[112:115], v133, s[16:19], s25 offen offset:128 nt
s_add_u32 s8, s30, 1048576
s_addc_u32 s9, s31, 0
s_mov_b32 s10, 11010048
s_mov_b32 s11, 0x20000
s_mul_i32 s27, s32, 56
s_add_u32 s27, s27, s33
s_lshl_b32 s27, s27, 8
s_add_u32 s27, s27, 3072
s_mov_b32 s56, s30
s_mov_b32 s57, s31
s_mov_b32 s58, 294912
s_mov_b32 s59, 0x20000
s_waitcnt lgkmcnt(0)
s_mul_i32 s52, s52, 1664525
s_add_u32 s52, s52, 1013904223
s_waitcnt vmcnt(8)
s_barrier
ds_read_b64 v[12:13], v9 offset:0
ds_read_b64 v[16:17], v9 offset:14336
ds_read_b64 v[14:15], v9 offset:64
ds_read_b64 v[18:19], v9 offset:14400
s_waitcnt vmcnt(4)
s_branch Lh_mid
Lh_loop:
s_add_u32 s15, s33, s23
s_and_b32 s15, s15, 3
s_lshl_b32 s14, s23, 2
s_add_u32 s15, s15, s14
s_add_u32 s23, s23, 1
s_and_b32 s14, s32, 4
s_xor_b32 s15, s15, s14
s_lshl_b32 s25, s15, 8
s_mul_i32 s14, s15, 16384
s_add_u32 s21, s24, s14
s_lshl_b32 s14, s15, 7
v_add_u32 v73, s14, v134
buffer_load_dwordx4 v[100:103], v132, s[16:19], s25 offen offset:0 nt
buffer_load_dwordx4 v[104:107], v132, s[16:19], s25 offen offset:128 nt
buffer_load_dwordx4 v[108:111], v133, s[16:19], s25 offen offset:0 nt
buffer_load_dwordx4 v[112:115], v133, s[16:19], s25 offen offset:128 nt
ds_read_b64 v[12:13], v9 offset:0
ds_read_b64 v[16:17], v9 offset:14336
ds_read_b64 v[14:15], v9 offset:64
ds_read_b64 v[18:19], v9 offset:14400
s_waitcnt vmcnt(6)
Lh_mid:
s_waitcnt lgkmcnt(0)
v_lshlrev_b32 v20, 16, v12
v_and_b32 v21, 0xffff0000, v12
v_lshlrev_b32 v28, 16, v16
v_and_b32 v29, 0xffff0000, v16
v_lshlrev_b32 v22, 16, v13
v_and_b32 v23, 0xffff0000, v13
v_lshlrev_b32 v30, 16, v17
v_and_b32 v31, 0xffff0000, v17
v_lshlrev_b32 v24, 16, v14
v_and_b32 v25, 0xffff0000, v14
v_lshlrev_b32 v32, 16, v18
v_and_b32 v33, 0xffff0000, v18
v_lshlrev_b32 v26, 16, v15
v_and_b32 v27, 0xffff0000, v15
v_lshlrev_b32 v34, 16, v19
v_and_b32 v35, 0xffff0000, v19
v_cvt_f32_i32 v36, v36
v_cvt_f32_i32 v37, v37
v_cvt_f32_i32 v38, v38
v_cvt_f32_i32 v39, v39
v_cvt_f32_i32 v40, v40
v_cvt_f32_i32 v41, v41
v_cvt_f32_i32 v42, v42
v_cvt_f32_i32 v43, v43
v_sub_f32 v36, v36, v28
v_sub_f32 v37, v37, v29
v_sub_f32 v38, v38, v30
v_sub_f32 v39, v39, v31
v_sub_f32 v40, v40, v32
v_sub_f32 v41, v41, v33
v_sub_f32 v42, v42, v34
v_sub_f32 v43, v43, v35
v_cvt_pk_bf16_f32 v12, v36, v37
v_cvt_pk_bf16_f32 v13, v38, v39
v_cvt_pk_bf16_f32 v14, v40, v41
v_cvt_pk_bf16_f32 v15, v42, v43
v_lshlrev_b32 v36, 16, v12
v_and_b32 v37, 0xffff0000, v12
v_lshlrev_b32 v38, 16, v13
v_and_b32 v39, 0xffff0000, v13
v_lshlrev_b32 v40, 16, v14
v_and_b32 v41, 0xffff0000, v14
v_lshlrev_b32 v42, 16, v15
v_and_b32 v43, 0xffff0000, v15
v_mul_f32 v36, v36, v20
v_mul_f32 v37, v37, v21
v_mul_f32 v38, v38, v22
v_mul_f32 v39, v39, v23
v_mul_f32 v40, v40, v24
v_mul_f32 v41, v41, v25
v_mul_f32 v42, v42, v26
v_mul_f32 v43, v43, v27
v_cvt_pk_bf16_f32 v36, v36, v37
v_cvt_pk_bf16_f32 v37, v38, v39
v_cvt_pk_bf16_f32 v38, v40, v41
v_cvt_pk_bf16_f32 v39, v42, v43
buffer_store_dwordx4 v[36:39], v140, s[8:11], s20 offen offset:0 sc1
v_cvt_f32_i32 v44, v44
v_cvt_f32_i32 v45, v45
v_cvt_f32_i32 v46, v46
v_cvt_f32_i32 v47, v47
v_cvt_f32_i32 v48, v48
v_cvt_f32_i32 v49, v49
v_cvt_f32_i32 v50, v50
v_cvt_f32_i32 v51, v51
v_sub_f32 v44, v44, v28
v_sub_f32 v45, v45, v29
v_sub_f32 v46, v46, v30
v_sub_f32 v47, v47, v31
v_sub_f32 v48, v48, v32
v_sub_f32 v49, v49, v33
v_sub_f32 v50, v50, v34
v_sub_f32 v51, v51, v35
v_cvt_pk_bf16_f32 v12, v44, v45
v_cvt_pk_bf16_f32 v13, v46, v47
v_cvt_pk_bf16_f32 v14, v48, v49
v_cvt_pk_bf16_f32 v15, v50, v51
v_lshlrev_b32 v44, 16, v12
v_and_b32 v45, 0xffff0000, v12
v_lshlrev_b32 v46, 16, v13
v_and_b32 v47, 0xffff0000, v13
v_lshlrev_b32 v48, 16, v14
v_and_b32 v49, 0xffff0000, v14
v_lshlrev_b32 v50, 16, v15
v_and_b32 v51, 0xffff0000, v15
v_mul_f32 v44, v44, v20
v_mul_f32 v45, v45, v21
v_mul_f32 v46, v46, v22
v_mul_f32 v47, v47, v23
v_mul_f32 v48, v48, v24
v_mul_f32 v49, v49, v25
v_mul_f32 v50, v50, v26
v_mul_f32 v51, v51, v27
v_cvt_pk_bf16_f32 v44, v44, v45
v_cvt_pk_bf16_f32 v45, v46, v47
v_cvt_pk_bf16_f32 v46, v48, v49
v_cvt_pk_bf16_f32 v47, v50, v51
buffer_store_dwordx4 v[44:47], v141, s[8:11], s20 offen offset:1024 sc1
s_add_u32 s15, s33, s23
s_and_b32 s15, s15, 3
s_lshl_b32 s14, s23, 2
s_add_u32 s15, s15, s14
s_add_u32 s23, s23, 1
s_and_b32 s14, s32, 4
s_xor_b32 s15, s15, s14
s_lshl_b32 s25, s15, 8
s_cmp_ge_u32 s15, 56
s_cselect_b32 s14, 0x40000000, 0
v_or_b32 v132, s14, v132
v_or_b32 v133, s14, v133
s_mul_i32 s14, s15, 16384
s_add_u32 s20, s24, s14
s_lshl_b32 s14, s15, 7
v_add_u32 v9, s14, v134
buffer_load_dwordx4 v[36:39], v132, s[16:19], s25 offen offset:0 nt
buffer_load_dwordx4 v[40:43], v132, s[16:19], s25 offen offset:128 nt
buffer_load_dwordx4 v[44:47], v133, s[16:19], s25 offen offset:0 nt
buffer_load_dwordx4 v[48:51], v133, s[16:19], s25 offen offset:128 nt
ds_read_b64 v[76:77], v73 offset:0
ds_read_b64 v[80:81], v73 offset:14336
ds_read_b64 v[78:79], v73 offset:64
ds_read_b64 v[82:83], v73 offset:14400
s_cmp_eq_u32 s23, 5
s_cselect_b32 s14, 1, s4
s_cmp_lg_u32 s14, 0
s_waitcnt vmcnt(6)
s_barrier
s_cbranch_scc1 Lh_nf1
v_mov_b32 v136, s52
v_mov_b32 v137, s52
v_mov_b32 v138, s52
v_mov_b32 v139, s52
s_mov_b64 exec, 0xff
buffer_store_dwordx4 v[136:139], v135, s[56:59], s27 offen sc1
s_mov_b64 exec, -1
s_add_u32 s27, s27, 2048
Lh_nf1:
s_waitcnt lgkmcnt(0)
v_lshlrev_b32 v84, 16, v76
v_and_b32 v85, 0xffff0000, v76
v_lshlrev_b32 v92, 16, v80
v_and_b32 v93, 0xffff0000, v80
v_lshlrev_b32 v86, 16, v77
v_and_b32 v87, 0xffff0000, v77
v_lshlrev_b32 v94, 16, v81
v_and_b32 v95, 0xffff0000, v81
v_lshlrev_b32 v88, 16, v78
v_and_b32 v89, 0xffff0000, v78
v_lshlrev_b32 v96, 16, v82
v_and_b32 v97, 0xffff0000, v82
v_lshlrev_b32 v90, 16, v79
v_and_b32 v91, 0xffff0000, v79
v_lshlrev_b32 v98, 16, v83
v_and_b32 v99, 0xffff0000, v83
v_cvt_f32_i32 v100, v100
v_cvt_f32_i32 v101, v101
v_cvt_f32_i32 v102, v102
v_cvt_f32_i32 v103, v103
v_cvt_f32_i32 v104, v104
v_cvt_f32_i32 v105, v105
v_cvt_f32_i32 v106, v106
v_cvt_f32_i32 v107, v107
v_sub_f32 v100, v100, v92
v_sub_f32 v101, v101, v93
v_sub_f32 v102, v102, v94
v_sub_f32 v103, v103, v95
v_sub_f32 v104, v104, v96
v_sub_f32 v105, v105, v97
v_sub_f32 v106, v106, v98
v_sub_f32 v107, v107, v99
v_cvt_pk_bf16_f32 v76, v100, v101
v_cvt_pk_bf16_f32 v77, v102, v103
v_cvt_pk_bf16_f32 v78, v104, v105
v_cvt_pk_bf16_f32 v79, v106, v107
v_lshlrev_b32 v100, 16, v76
v_and_b32 v101, 0xffff0000, v76
v_lshlrev_b32 v102, 16, v77
v_and_b32 v103, 0xffff0000, v77
v_lshlrev_b32 v104, 16, v78
v_and_b32 v105, 0xffff0000, v78
v_lshlrev_b32 v106, 16, v79
v_and_b32 v107, 0xffff0000, v79
v_mul_f32 v100, v100, v84
v_mul_f32 v101, v101, v85
v_mul_f32 v102, v102, v86
v_mul_f32 v103, v103, v87
v_mul_f32 v104, v104, v88
v_mul_f32 v105, v105, v89
v_mul_f32 v106, v106, v90
v_mul_f32 v107, v107, v91
v_cvt_pk_bf16_f32 v100, v100, v101
v_cvt_pk_bf16_f32 v101, v102, v103
v_cvt_pk_bf16_f32 v102, v104, v105
v_cvt_pk_bf16_f32 v103, v106, v107
buffer_store_dwordx4 v[100:103], v140, s[8:11], s21 offen offset:0 sc1
v_cvt_f32_i32 v108, v108
v_cvt_f32_i32 v109, v109
v_cvt_f32_i32 v110, v110
v_cvt_f32_i32 v111, v111
v_cvt_f32_i32 v112, v112
v_cvt_f32_i32 v113, v113
v_cvt_f32_i32 v114, v114
v_cvt_f32_i32 v115, v115
v_sub_f32 v108, v108, v92
v_sub_f32 v109, v109, v93
v_sub_f32 v110, v110, v94
v_sub_f32 v111, v111, v95
v_sub_f32 v112, v112, v96
v_sub_f32 v113, v113, v97
v_sub_f32 v114, v114, v98
v_sub_f32 v115, v115, v99
v_cvt_pk_bf16_f32 v76, v108, v109
v_cvt_pk_bf16_f32 v77, v110, v111
v_cvt_pk_bf16_f32 v78, v112, v113
v_cvt_pk_bf16_f32 v79, v114, v115
v_lshlrev_b32 v108, 16, v76
v_and_b32 v109, 0xffff0000, v76
v_lshlrev_b32 v110, 16, v77
v_and_b32 v111, 0xffff0000, v77
v_lshlrev_b32 v112, 16, v78
v_and_b32 v113, 0xffff0000, v78
v_lshlrev_b32 v114, 16, v79
v_and_b32 v115, 0xffff0000, v79
v_mul_f32 v108, v108, v84
v_mul_f32 v109, v109, v85
v_mul_f32 v110, v110, v86
v_mul_f32 v111, v111, v87
v_mul_f32 v112, v112, v88
v_mul_f32 v113, v113, v89
v_mul_f32 v114, v114, v90
v_mul_f32 v115, v115, v91
v_cvt_pk_bf16_f32 v108, v108, v109
v_cvt_pk_bf16_f32 v109, v110, v111
v_cvt_pk_bf16_f32 v110, v112, v113
v_cvt_pk_bf16_f32 v111, v114, v115
buffer_store_dwordx4 v[108:111], v141, s[8:11], s21 offen offset:1024 sc1
s_cmp_lt_u32 s23, 15
s_cbranch_scc1 Lh_loop
Lh_skip:
s_cmp_lg_u32 s4, 0
s_waitcnt vmcnt(0)
s_barrier
s_cbranch_scc1 Lh_nf
v_mov_b32 v136, s52
v_mov_b32 v137, s52
v_mov_b32 v138, s52
v_mov_b32 v139, s52
s_mov_b64 exec, 0xff
buffer_store_dwordx4 v[136:139], v135, s[56:59], s27 offen sc1
s_mov_b64 exec, -1
Lh_nf:
s_branch L_role
L_c:
s_and_b32 s32, s2, 1
s_bfe_u32 s33, s2, 0x20003
s_lshl2_add_u32 s32, s32, s33
s_bfe_u32 s14, s2, 0x20001
s_mul_i32 s35, s14, 7
s_lshr_b32 s34, s2, 5
s_add_u32 s33, s35, s34
s_add_u32 s35, s35, 2
s_lshr_b32 s35, s35, 2
s_add_u32 s54, s34, s35
s_add_u32 s35, s33, 2
s_lshr_b32 s35, s35, 2
s_sub_u32 s54, s54, s35
s_cmp_ge_u32 s54, 4
s_cselect_b32 s54, 16, s54
s_and_b32 s35, s33, 3
s_cmp_eq_u32 s35, 1
s_cselect_b32 s54, 16, s54
s_lshl2_add_u32 s54, s14, s54
s_lshr_b32 s15, s54, 1
s_and_b32 s29, s54, 1
s_lshl_b32 s29, s29, 2
s_add_u32 s29, s29, s3
s_lshl_b32 s14, s32, 3
s_add_u32 s14, s14, s29
s_mul_i32 s34, s14, 229376
s_lshl_b32 s35, s15, 8
s_add_u32 s34, s34, s35
s_lshr_b32 s14, s14, 2
s_mul_i32 s35, s14, 7168
s_lshl_b32 s14, s15, 7
s_add_u32 s35, s35, s14
v_lshrrev_b32 v64, 3, v0
v_and_b32 v69, 7, v0
v_mul_u32_u24 v64, 14336, v64
v_lshl_add_u32 v64, v69, 4, v64
v_add_u32 v64, s34, v64
v_add_u32 v65, 114688, v64
v_lshl_add_u32 v69, v69, 3, s35
v_lshlrev_b32 v68, 4, v0
s_mul_i32 s28, s32, 56
s_add_u32 s28, s28, s15
s_lshl_b32 s28, s28, 3
s_add_u32 s28, s28, s29
s_lshl_b32 s28, s28, 11
s_waitcnt lgkmcnt(0)
s_load_dword s52, s[30:31], 258048
s_cmp_ge_u32 s54, 16
s_cbranch_scc1 Lc_nodq0
global_load_dwordx2 v[72:73], v69, s[40:41] offset:0
global_load_dwordx2 v[76:77], v69, s[42:43] offset:0
global_load_dwordx2 v[74:75], v69, s[40:41] offset:64
global_load_dwordx2 v[78:79], v69, s[42:43] offset:64
global_load_dwordx4 v[96:99], v64, s[38:39] offset:0 nt
global_load_dwordx4 v[100:103], v64, s[38:39] offset:128 nt
global_load_dwordx4 v[104:107], v65, s[38:39] offset:0 nt
global_load_dwordx4 v[108:111], v65, s[38:39] offset:128 nt
Lc_nodq0:
s_add_u32 s8, s30, 1048576
s_addc_u32 s9, s31, 0
s_mov_b32 s10, 11010048
s_mov_b32 s11, 0x20000
v_lshlrev_b32 v248, 4, v0
v_and_b32 v240, 15, v0
v_lshrrev_b32 v241, 4, v0
v_lshrrev_b32 v242, 1, v240
v_xor_b32 v242, v242, v241
v_lshlrev_b32 v242, 4, v242
v_lshl_add_u32 v242, v240, 7, v242
s_lshr_b32 s14, s3, 1
s_lshl_b32 s14, s14, 13
v_add_u32 v230, s14, v242
v_xor_b32 v231, 64, v230
v_mov_b32 v216, v242
v_xor_b32 v217, 64, v216
v_bfe_u32 v240, v0, 2, 3
v_mul_u32_u24 v240, 1056, v240
v_lshrrev_b32 v241, 5, v0
v_lshl_add_u32 v240, v241, 8, v240
v_and_b32 v241, 3, v0
v_lshl_add_u32 v240, v241, 3, v240
s_and_b32 s14, s3, 1
s_lshl_b32 s14, s14, 7
v_add_u32 v234, s14, v240
s_lshl_b32 s14, s3, 6
v_add_u32 v220, s14, v240
v_add_u32 v232, 66560, v230
v_add_u32 v233, 66560, v231
v_add_u32 v218, 66560, v216
v_add_u32 v219, 66560, v217
v_add_u32 v235, 66560, v234
v_add_u32 v221, 66560, v220
s_lshl_b32 s14, s3, 12
v_add_u32 v224, s14, v248
v_add_u32 v225, 33280, v224
v_add_u32 v226, 66560, v224
v_bfe_u32 v240, v0, 1, 3
v_mul_u32_u24 v240, 1040, v240
v_lshrrev_b32 v241, 4, v0
v_lshl_add_u32 v240, v241, 8, v240
v_and_b32 v242, 1, v0
v_lshl_add_u32 v240, v242, 7, v240
v_add_u32 v227, 99840, v240
s_lshr_b32 s14, s3, 1
s_mul_i32 s14, s14, 16640
s_and_b32 s34, s3, 1
s_mul_i32 s34, s34, 4160
s_add_u32 s14, s14, s34
s_add_u32 s14, s14, 99840
v_add_u32 v228, s14, v248
v_and_b32 v242, 15, v0
v_lshlrev_b32 v242, 4, v242
v_mul_u32_u24 v241, 28672, v241
v_add_u32 v229, v242, v241
v_mov_b32 v0, 0
v_mov_b32 v1, 0
v_mov_b32 v2, 0
v_mov_b32 v3, 0
v_mov_b32 v4, 0
v_mov_b32 v5, 0
v_mov_b32 v6, 0
v_mov_b32 v7, 0
v_mov_b32 v8, 0
v_mov_b32 v9, 0
v_mov_b32 v10, 0
v_mov_b32 v11, 0
v_mov_b32 v12, 0
v_mov_b32 v13, 0
v_mov_b32 v14, 0
v_mov_b32 v15, 0
v_mov_b32 v16, 0
v_mov_b32 v17, 0
v_mov_b32 v18, 0
v_mov_b32 v19, 0
v_mov_b32 v20, 0
v_mov_b32 v21, 0
v_mov_b32 v22, 0
v_mov_b32 v23, 0
v_mov_b32 v24, 0
v_mov_b32 v25, 0
v_mov_b32 v26, 0
v_mov_b32 v27, 0
v_mov_b32 v28, 0
v_mov_b32 v29, 0
v_mov_b32 v30, 0
v_mov_b32 v31, 0
v_mov_b32 v32, 0
v_mov_b32 v33, 0
v_mov_b32 v34, 0
v_mov_b32 v35, 0
v_mov_b32 v36, 0
v_mov_b32 v37, 0
v_mov_b32 v38, 0
v_mov_b32 v39, 0
v_mov_b32 v40, 0
v_mov_b32 v41, 0
v_mov_b32 v42, 0
v_mov_b32 v43, 0
v_mov_b32 v44, 0
v_mov_b32 v45, 0
v_mov_b32 v46, 0
v_mov_b32 v47, 0
v_mov_b32 v48, 0
v_mov_b32 v49, 0
v_mov_b32 v50, 0
v_mov_b32 v51, 0
v_mov_b32 v52, 0
v_mov_b32 v53, 0
v_mov_b32 v54, 0
v_mov_b32 v55, 0
v_mov_b32 v56, 0
v_mov_b32 v57, 0
v_mov_b32 v58, 0
v_mov_b32 v59, 0
v_mov_b32 v60, 0
v_mov_b32 v61, 0
v_mov_b32 v62, 0
v_mov_b32 v63, 0
v_mov_b32 v136, 0
v_mov_b32 v137, 0
v_mov_b32 v138, 0
v_mov_b32 v139, 0
v_mov_b32 v140, 0
v_mov_b32 v141, 0
v_mov_b32 v142, 0
v_mov_b32 v143, 0
v_mov_b32 v144, 0
v_mov_b32 v145, 0
v_mov_b32 v146, 0
v_mov_b32 v147, 0
v_mov_b32 v148, 0
v_mov_b32 v149, 0
v_mov_b32 v150, 0
v_mov_b32 v151, 0
v_mov_b32 v152, 0
v_mov_b32 v153, 0
v_mov_b32 v154, 0
v_mov_b32 v155, 0
v_mov_b32 v156, 0
v_mov_b32 v157, 0
v_mov_b32 v158, 0
v_mov_b32 v159, 0
v_mov_b32 v160, 0
v_mov_b32 v161, 0
v_mov_b32 v162, 0
v_mov_b32 v163, 0
v_mov_b32 v164, 0
v_mov_b32 v165, 0
v_mov_b32 v166, 0
v_mov_b32 v167, 0
s_lshr_b32 s24, s6, 2
s_lshl_b32 s24, s24, 5
s_lshl_b32 s34, s7, 2
s_add_u32 s24, s24, s34
s_add_u32 s24, s24, s3
s_lshl_b32 s24, s24, 2
s_and_b32 s34, s6, 3
s_add_u32 s24, s24, s34
s_lshl_b32 s24, s24, 12
s_add_u32 s16, s30, 13631488
s_addc_u32 s17, s31, 0
s_mov_b32 s18, 4194304
s_mov_b32 s19, 0x20000
s_mov_b32 s56, s30
s_mov_b32 s57, s31
s_mov_b32 s58, 294912
s_mov_b32 s59, 0x20000
s_waitcnt lgkmcnt(0)
s_mul_i32 s52, s52, 1664525
s_add_u32 s52, s52, 1013904223
s_cmp_ge_u32 s54, 16
s_cbranch_scc1 Lc_nodq1
s_waitcnt vmcnt(4)
v_lshlrev_b32 v80, 16, v72
v_and_b32 v81, 0xffff0000, v72
v_lshlrev_b32 v88, 16, v76
v_and_b32 v89, 0xffff0000, v76
v_lshlrev_b32 v82, 16, v73
v_and_b32 v83, 0xffff0000, v73
v_lshlrev_b32 v90, 16, v77
v_and_b32 v91, 0xffff0000, v77
v_lshlrev_b32 v84, 16, v74
v_and_b32 v85, 0xffff0000, v74
v_lshlrev_b32 v92, 16, v78
v_and_b32 v93, 0xffff0000, v78
v_lshlrev_b32 v86, 16, v75
v_and_b32 v87, 0xffff0000, v75
v_lshlrev_b32 v94, 16, v79
v_and_b32 v95, 0xffff0000, v79
s_waitcnt vmcnt(2)
v_cvt_f32_i32 v96, v96
v_cvt_f32_i32 v97, v97
v_cvt_f32_i32 v98, v98
v_cvt_f32_i32 v99, v99
v_cvt_f32_i32 v100, v100
v_cvt_f32_i32 v101, v101
v_cvt_f32_i32 v102, v102
v_cvt_f32_i32 v103, v103
v_sub_f32 v96, v96, v88
v_sub_f32 v97, v97, v89
v_sub_f32 v98, v98, v90
v_sub_f32 v99, v99, v91
v_sub_f32 v100, v100, v92
v_sub_f32 v101, v101, v93
v_sub_f32 v102, v102, v94
v_sub_f32 v103, v103, v95
v_cvt_pk_bf16_f32 v72, v96, v97
v_cvt_pk_bf16_f32 v73, v98, v99
v_cvt_pk_bf16_f32 v74, v100, v101
v_cvt_pk_bf16_f32 v75, v102, v103
v_lshlrev_b32 v96, 16, v72
v_and_b32 v97, 0xffff0000, v72
v_lshlrev_b32 v98, 16, v73
v_and_b32 v99, 0xffff0000, v73
v_lshlrev_b32 v100, 16, v74
v_and_b32 v101, 0xffff0000, v74
v_lshlrev_b32 v102, 16, v75
v_and_b32 v103, 0xffff0000, v75
v_mul_f32 v96, v96, v80
v_mul_f32 v97, v97, v81
v_mul_f32 v98, v98, v82
v_mul_f32 v99, v99, v83
v_mul_f32 v100, v100, v84
v_mul_f32 v101, v101, v85
v_mul_f32 v102, v102, v86
v_mul_f32 v103, v103, v87
v_cvt_pk_bf16_f32 v96, v96, v97
v_cvt_pk_bf16_f32 v97, v98, v99
v_cvt_pk_bf16_f32 v98, v100, v101
v_cvt_pk_bf16_f32 v99, v102, v103
buffer_store_dwordx4 v[96:99], v68, s[8:11], s28 offen offset:0 sc1
s_waitcnt vmcnt(1)
v_cvt_f32_i32 v104, v104
v_cvt_f32_i32 v105, v105
v_cvt_f32_i32 v106, v106
v_cvt_f32_i32 v107, v107
v_cvt_f32_i32 v108, v108
v_cvt_f32_i32 v109, v109
v_cvt_f32_i32 v110, v110
v_cvt_f32_i32 v111, v111
v_sub_f32 v104, v104, v88
v_sub_f32 v105, v105, v89
v_sub_f32 v106, v106, v90
v_sub_f32 v107, v107, v91
v_sub_f32 v108, v108, v92
v_sub_f32 v109, v109, v93
v_sub_f32 v110, v110, v94
v_sub_f32 v111, v111, v95
v_cvt_pk_bf16_f32 v72, v104, v105
v_cvt_pk_bf16_f32 v73, v106, v107
v_cvt_pk_bf16_f32 v74, v108, v109
v_cvt_pk_bf16_f32 v75, v110, v111
v_lshlrev_b32 v104, 16, v72
v_and_b32 v105, 0xffff0000, v72
v_lshlrev_b32 v106, 16, v73
v_and_b32 v107, 0xffff0000, v73
v_lshlrev_b32 v108, 16, v74
v_and_b32 v109, 0xffff0000, v74
v_lshlrev_b32 v110, 16, v75
v_and_b32 v111, 0xffff0000, v75
v_mul_f32 v104, v104, v80
v_mul_f32 v105, v105, v81
v_mul_f32 v106, v106, v82
v_mul_f32 v107, v107, v83
v_mul_f32 v108, v108, v84
v_mul_f32 v109, v109, v85
v_mul_f32 v110, v110, v86
v_mul_f32 v111, v111, v87
v_cvt_pk_bf16_f32 v104, v104, v105
v_cvt_pk_bf16_f32 v105, v106, v107
v_cvt_pk_bf16_f32 v106, v108, v109
v_cvt_pk_bf16_f32 v107, v110, v111
buffer_store_dwordx4 v[104:107], v68, s[8:11], s28 offen offset:1024 sc1
Lc_nodq1:
s_mov_b32 s23, 4
s_barrier
ds_read_b64_tr_b16 v[184:185], v220 offset:16384
ds_read_b64_tr_b16 v[186:187], v220 offset:16896
ds_read_b128 v[168:171], v216 offset:0
ds_read_b64_tr_b16 v[188:189], v220 offset:16416
ds_read_b64_tr_b16 v[190:191], v220 offset:16928
ds_read_b128 v[172:175], v216 offset:2048
ds_read_b128 v[176:179], v216 offset:4096
ds_read_b128 v[180:183], v216 offset:6144
s_branch Lx_mid
Lx_loop:
s_barrier
v_mfma_f32_16x16x32_bf16 v[136:139], v[208:211], v[192:195], v[136:139]
ds_read_b64_tr_b16 v[184:185], v220 offset:16384
v_mfma_f32_16x16x32_bf16 v[140:143], v[212:215], v[192:195], v[140:143]
ds_read_b64_tr_b16 v[186:187], v220 offset:16896
v_mfma_f32_16x16x32_bf16 v[148:151], v[212:215], v[196:199], v[148:151]
ds_read_b128 v[168:171], v216 offset:0
v_mfma_f32_16x16x32_bf16 v[144:147], v[208:211], v[196:199], v[144:147]
ds_read_b64_tr_b16 v[188:189], v220 offset:16416
v_mfma_f32_16x16x32_bf16 v[152:155], v[208:211], v[200:203], v[152:155]
ds_read_b64_tr_b16 v[190:191], v220 offset:16928
v_mfma_f32_16x16x32_bf16 v[156:159], v[212:215], v[200:203], v[156:159]
ds_read_b128 v[172:175], v216 offset:2048
v_mfma_f32_16x16x32_bf16 v[164:167], v[212:215], v[204:207], v[164:167]
ds_read_b128 v[176:179], v216 offset:4096
v_mfma_f32_16x16x32_bf16 v[160:163], v[208:211], v[204:207], v[160:163]
ds_read_b128 v[180:183], v216 offset:6144
Lx_mid:
s_waitcnt lgkmcnt(5)
v_mfma_f32_16x16x32_bf16 v[136:139], v[184:187], v[168:171], v[136:139]
ds_read_b64_tr_b16 v[208:209], v220 offset:24832
ds_read_b64_tr_b16 v[210:211], v220 offset:25344
s_waitcnt lgkmcnt(5)
v_mfma_f32_16x16x32_bf16 v[140:143], v[188:191], v[168:171], v[140:143]
ds_read_b128 v[192:195], v217 offset:0
ds_read_b64_tr_b16 v[212:213], v220 offset:24864
s_waitcnt lgkmcnt(6)
v_mfma_f32_16x16x32_bf16 v[148:151], v[188:191], v[172:175], v[148:151]
ds_read_b64_tr_b16 v[214:215], v220 offset:25376
ds_read_b128 v[196:199], v217 offset:2048
v_mfma_f32_16x16x32_bf16 v[144:147], v[184:187], v[172:175], v[144:147]
ds_read_b128 v[200:203], v217 offset:4096
ds_read_b128 v[204:207], v217 offset:6144
s_waitcnt lgkmcnt(9)
v_mfma_f32_16x16x32_bf16 v[152:155], v[184:187], v[176:179], v[152:155]
v_mfma_f32_16x16x32_bf16 v[156:159], v[188:191], v[176:179], v[156:159]
s_waitcnt lgkmcnt(8)
v_mfma_f32_16x16x32_bf16 v[164:167], v[188:191], v[180:183], v[164:167]
v_mfma_f32_16x16x32_bf16 v[160:163], v[184:187], v[180:183], v[160:163]
s_waitcnt lgkmcnt(0)
s_barrier
v_mfma_f32_16x16x32_bf16 v[136:139], v[208:211], v[192:195], v[136:139]
ds_read_b64_tr_b16 v[184:185], v220 offset:49664
v_mfma_f32_16x16x32_bf16 v[140:143], v[212:215], v[192:195], v[140:143]
ds_read_b64_tr_b16 v[186:187], v220 offset:50176
v_mfma_f32_16x16x32_bf16 v[148:151], v[212:215], v[196:199], v[148:151]
ds_read_b128 v[168:171], v216 offset:33280
v_mfma_f32_16x16x32_bf16 v[144:147], v[208:211], v[196:199], v[144:147]
ds_read_b64_tr_b16 v[188:189], v220 offset:49696
v_mfma_f32_16x16x32_bf16 v[152:155], v[208:211], v[200:203], v[152:155]
ds_read_b64_tr_b16 v[190:191], v220 offset:50208
v_mfma_f32_16x16x32_bf16 v[156:159], v[212:215], v[200:203], v[156:159]
ds_read_b128 v[172:175], v216 offset:35328
v_mfma_f32_16x16x32_bf16 v[164:167], v[212:215], v[204:207], v[164:167]
ds_read_b128 v[176:179], v216 offset:37376
v_mfma_f32_16x16x32_bf16 v[160:163], v[208:211], v[204:207], v[160:163]
ds_read_b128 v[180:183], v216 offset:39424
s_waitcnt lgkmcnt(5)
v_mfma_f32_16x16x32_bf16 v[136:139], v[184:187], v[168:171], v[136:139]
ds_read_b64_tr_b16 v[208:209], v220 offset:58112
ds_read_b64_tr_b16 v[210:211], v220 offset:58624
s_waitcnt lgkmcnt(5)
v_mfma_f32_16x16x32_bf16 v[140:143], v[188:191], v[168:171], v[140:143]
ds_read_b128 v[192:195], v217 offset:33280
ds_read_b64_tr_b16 v[212:213], v220 offset:58144
s_waitcnt lgkmcnt(6)
v_mfma_f32_16x16x32_bf16 v[148:151], v[188:191], v[172:175], v[148:151]
ds_read_b64_tr_b16 v[214:215], v220 offset:58656
ds_read_b128 v[196:199], v217 offset:35328
v_mfma_f32_16x16x32_bf16 v[144:147], v[184:187], v[172:175], v[144:147]
ds_read_b128 v[200:203], v217 offset:37376
ds_read_b128 v[204:207], v217 offset:39424
s_waitcnt lgkmcnt(9)
v_mfma_f32_16x16x32_bf16 v[152:155], v[184:187], v[176:179], v[152:155]
v_mfma_f32_16x16x32_bf16 v[156:159], v[188:191], v[176:179], v[156:159]
s_waitcnt lgkmcnt(8)
v_mfma_f32_16x16x32_bf16 v[164:167], v[188:191], v[180:183], v[164:167]
v_mfma_f32_16x16x32_bf16 v[160:163], v[184:187], v[180:183], v[160:163]
s_waitcnt lgkmcnt(0)
s_barrier
v_mfma_f32_16x16x32_bf16 v[136:139], v[208:211], v[192:195], v[136:139]
ds_read_b64_tr_b16 v[184:185], v221 offset:16384
v_mfma_f32_16x16x32_bf16 v[140:143], v[212:215], v[192:195], v[140:143]
ds_read_b64_tr_b16 v[186:187], v221 offset:16896
v_mfma_f32_16x16x32_bf16 v[148:151], v[212:215], v[196:199], v[148:151]
ds_read_b128 v[168:171], v218 offset:0
v_mfma_f32_16x16x32_bf16 v[144:147], v[208:211], v[196:199], v[144:147]
ds_read_b64_tr_b16 v[188:189], v221 offset:16416
v_mfma_f32_16x16x32_bf16 v[152:155], v[208:211], v[200:203], v[152:155]
ds_read_b64_tr_b16 v[190:191], v221 offset:16928
v_mfma_f32_16x16x32_bf16 v[156:159], v[212:215], v[200:203], v[156:159]
ds_read_b128 v[172:175], v218 offset:2048
v_mfma_f32_16x16x32_bf16 v[164:167], v[212:215], v[204:207], v[164:167]
ds_read_b128 v[176:179], v218 offset:4096
v_mfma_f32_16x16x32_bf16 v[160:163], v[208:211], v[204:207], v[160:163]
ds_read_b128 v[180:183], v218 offset:6144
s_waitcnt lgkmcnt(5)
v_mfma_f32_16x16x32_bf16 v[136:139], v[184:187], v[168:171], v[136:139]
ds_read_b64_tr_b16 v[208:209], v221 offset:24832
ds_read_b64_tr_b16 v[210:211], v221 offset:25344
s_waitcnt lgkmcnt(5)
v_mfma_f32_16x16x32_bf16 v[140:143], v[188:191], v[168:171], v[140:143]
ds_read_b128 v[192:195], v219 offset:0
ds_read_b64_tr_b16 v[212:213], v221 offset:24864
s_waitcnt lgkmcnt(6)
v_mfma_f32_16x16x32_bf16 v[148:151], v[188:191], v[172:175], v[148:151]
ds_read_b64_tr_b16 v[214:215], v221 offset:25376
ds_read_b128 v[196:199], v219 offset:2048
v_mfma_f32_16x16x32_bf16 v[144:147], v[184:187], v[172:175], v[144:147]
ds_read_b128 v[200:203], v219 offset:4096
ds_read_b128 v[204:207], v219 offset:6144
s_waitcnt lgkmcnt(9)
v_mfma_f32_16x16x32_bf16 v[152:155], v[184:187], v[176:179], v[152:155]
v_mfma_f32_16x16x32_bf16 v[156:159], v[188:191], v[176:179], v[156:159]
s_waitcnt lgkmcnt(8)
v_mfma_f32_16x16x32_bf16 v[164:167], v[188:191], v[180:183], v[164:167]
v_mfma_f32_16x16x32_bf16 v[160:163], v[184:187], v[180:183], v[160:163]
s_waitcnt vmcnt(0) lgkmcnt(0)
s_barrier
v_mfma_f32_16x16x32_bf16 v[136:139], v[208:211], v[192:195], v[136:139]
ds_read_b64_tr_b16 v[184:185], v221 offset:49664
v_mfma_f32_16x16x32_bf16 v[140:143], v[212:215], v[192:195], v[140:143]
ds_read_b64_tr_b16 v[186:187], v221 offset:50176
v_mfma_f32_16x16x32_bf16 v[148:151], v[212:215], v[196:199], v[148:151]
ds_read_b128 v[168:171], v218 offset:33280
v_mfma_f32_16x16x32_bf16 v[144:147], v[208:211], v[196:199], v[144:147]
ds_read_b64_tr_b16 v[188:189], v221 offset:49696
v_mfma_f32_16x16x32_bf16 v[152:155], v[208:211], v[200:203], v[152:155]
ds_read_b64_tr_b16 v[190:191], v221 offset:50208
v_mfma_f32_16x16x32_bf16 v[156:159], v[212:215], v[200:203], v[156:159]
ds_read_b128 v[172:175], v218 offset:35328
v_mfma_f32_16x16x32_bf16 v[164:167], v[212:215], v[204:207], v[164:167]
ds_read_b128 v[176:179], v218 offset:37376
v_mfma_f32_16x16x32_bf16 v[160:163], v[208:211], v[204:207], v[160:163]
ds_read_b128 v[180:183], v218 offset:39424
s_waitcnt lgkmcnt(5)
v_mfma_f32_16x16x32_bf16 v[136:139], v[184:187], v[168:171], v[136:139]
ds_read_b64_tr_b16 v[208:209], v221 offset:58112
ds_read_b64_tr_b16 v[210:211], v221 offset:58624
s_waitcnt lgkmcnt(5)
v_mfma_f32_16x16x32_bf16 v[140:143], v[188:191], v[168:171], v[140:143]
ds_read_b128 v[192:195], v219 offset:33280
ds_read_b64_tr_b16 v[212:213], v221 offset:58144
s_waitcnt lgkmcnt(6)
v_mfma_f32_16x16x32_bf16 v[148:151], v[188:191], v[172:175], v[148:151]
ds_read_b64_tr_b16 v[214:215], v221 offset:58656
ds_read_b128 v[196:199], v219 offset:35328
v_mfma_f32_16x16x32_bf16 v[144:147], v[184:187], v[172:175], v[144:147]
ds_read_b128 v[200:203], v219 offset:37376
ds_read_b128 v[204:207], v219 offset:39424
s_waitcnt lgkmcnt(9)
v_mfma_f32_16x16x32_bf16 v[152:155], v[184:187], v[176:179], v[152:155]
v_mfma_f32_16x16x32_bf16 v[156:159], v[188:191], v[176:179], v[156:159]
s_waitcnt lgkmcnt(8)
v_mfma_f32_16x16x32_bf16 v[164:167], v[188:191], v[180:183], v[164:167]
v_mfma_f32_16x16x32_bf16 v[160:163], v[184:187], v[180:183], v[160:163]
s_sub_u32 s23, s23, 1
s_cmp_lg_u32 s23, 0
s_waitcnt lgkmcnt(0)
s_cbranch_scc1 Lx_loop
s_cmp_lg_u32 s5, 0
s_cbranch_scc1 Lc_h
s_barrier
v_mfma_f32_16x16x32_bf16 v[136:139], v[208:211], v[192:195], v[136:139]
ds_read_b64_tr_b16 v[96:97], v234 offset:16384
v_mfma_f32_16x16x32_bf16 v[140:143], v[212:215], v[192:195], v[140:143]
ds_read_b64_tr_b16 v[98:99], v234 offset:16896
v_mfma_f32_16x16x32_bf16 v[148:151], v[212:215], v[196:199], v[148:151]
ds_read_b64_tr_b16 v[100:101], v234 offset:24832
v_mfma_f32_16x16x32_bf16 v[144:147], v[208:211], v[196:199], v[144:147]
ds_read_b64_tr_b16 v[102:103], v234 offset:25344
v_mfma_f32_16x16x32_bf16 v[152:155], v[208:211], v[200:203], v[152:155]
ds_read_b128 v[64:67], v230 offset:0
v_mfma_f32_16x16x32_bf16 v[156:159], v[212:215], v[200:203], v[156:159]
ds_read_b128 v[68:71], v231 offset:0
v_mfma_f32_16x16x32_bf16 v[164:167], v[212:215], v[204:207], v[164:167]
ds_read_b128 v[72:75], v230 offset:2048
v_mfma_f32_16x16x32_bf16 v[160:163], v[208:211], v[204:207], v[160:163]
ds_read_b128 v[76:79], v231 offset:2048
ds_read_b128 v[80:83], v230 offset:4096
ds_read_b128 v[84:87], v231 offset:4096
ds_read_b128 v[88:91], v230 offset:6144
ds_read_b128 v[92:95], v231 offset:6144
ds_read_b64_tr_b16 v[104:105], v234 offset:16416
ds_read_b64_tr_b16 v[106:107], v234 offset:16928
s_lshl_b32 s25, s32, 2
s_add_u32 s25, s25, s3
s_mov_b32 s23, 14
v_cvt_pk_bf16_f32 v240, v136, v137
v_cvt_pk_bf16_f32 v241, v138, v139
v_cvt_pk_bf16_f32 v242, v140, v141
v_cvt_pk_bf16_f32 v243, v142, v143
buffer_store_dwordx4 v[240:243], v248, s[16:19], s24 offen offset:0 sc1
v_cvt_pk_bf16_f32 v244, v144, v145
v_cvt_pk_bf16_f32 v245, v146, v147
v_cvt_pk_bf16_f32 v246, v148, v149
v_cvt_pk_bf16_f32 v247, v150, v151
buffer_store_dwordx4 v[244:247], v248, s[16:19], s24 offen offset:1024 sc1
v_cvt_pk_bf16_f32 v240, v152, v153
v_cvt_pk_bf16_f32 v241, v154, v155
v_cvt_pk_bf16_f32 v242, v156, v157
v_cvt_pk_bf16_f32 v243, v158, v159
buffer_store_dwordx4 v[240:243], v248, s[16:19], s24 offen offset:2048 sc1
v_cvt_pk_bf16_f32 v244, v160, v161
v_cvt_pk_bf16_f32 v245, v162, v163
v_cvt_pk_bf16_f32 v246, v164, v165
v_cvt_pk_bf16_f32 v247, v166, v167
buffer_store_dwordx4 v[244:247], v248, s[16:19], s24 offen offset:3072 sc1
s_lshr_b32 s34, s3, 1
s_lshl_b32 s24, s32, 1
s_add_u32 s24, s24, s34
s_mul_i32 s24, s24, 458752
s_and_b32 s34, s3, 1
s_lshl_b32 s35, s33, 1
s_add_u32 s34, s34, s35
s_lshl_b32 s34, s34, 12
s_add_u32 s24, s24, s34
s_add_u32 s16, s30, 20971520
s_addc_u32 s17, s31, 0
s_mov_b32 s18, 7340032
s_mov_b32 s19, 0x20000
s_add_u32 s26, s24, 229376
s_waitcnt lgkmcnt(0)
s_branch Lb_mid
Lb_loop:
s_barrier
v_mfma_f32_16x16x32_bf16 v[8:11], v[128:131], v[112:115], v[8:11]
ds_read_b64_tr_b16 v[96:97], v234 offset:16384
v_mfma_f32_16x16x32_bf16 v[8:11], v[132:135], v[116:119], v[8:11]
ds_read_b64_tr_b16 v[98:99], v234 offset:16896
v_mfma_f32_16x16x32_bf16 v[24:27], v[136:139], v[112:115], v[24:27]
ds_read_b64_tr_b16 v[100:101], v234 offset:24832
v_mfma_f32_16x16x32_bf16 v[24:27], v[140:143], v[116:119], v[24:27]
ds_read_b64_tr_b16 v[102:103], v234 offset:25344
v_mfma_f32_16x16x32_bf16 v[40:43], v[144:147], v[112:115], v[40:43]
ds_read_b128 v[64:67], v230 offset:0
v_mfma_f32_16x16x32_bf16 v[40:43], v[148:151], v[116:119], v[40:43]
ds_read_b128 v[68:71], v231 offset:0
v_mfma_f32_16x16x32_bf16 v[56:59], v[152:155], v[112:115], v[56:59]
ds_read_b128 v[72:75], v230 offset:2048
v_mfma_f32_16x16x32_bf16 v[56:59], v[156:159], v[116:119], v[56:59]
ds_read_b128 v[76:79], v231 offset:2048
v_mfma_f32_16x16x32_bf16 v[60:63], v[152:155], v[120:123], v[60:63]
ds_read_b128 v[80:83], v230 offset:4096
v_mfma_f32_16x16x32_bf16 v[60:63], v[156:159], v[124:127], v[60:63]
ds_read_b128 v[84:87], v231 offset:4096
v_mfma_f32_16x16x32_bf16 v[44:47], v[144:147], v[120:123], v[44:47]
ds_read_b128 v[88:91], v230 offset:6144
v_mfma_f32_16x16x32_bf16 v[44:47], v[148:151], v[124:127], v[44:47]
ds_read_b128 v[92:95], v231 offset:6144
v_mfma_f32_16x16x32_bf16 v[28:31], v[136:139], v[120:123], v[28:31]
ds_read_b64_tr_b16 v[104:105], v234 offset:16416
v_mfma_f32_16x16x32_bf16 v[28:31], v[140:143], v[124:127], v[28:31]
ds_read_b64_tr_b16 v[106:107], v234 offset:16928
v_mfma_f32_16x16x32_bf16 v[12:15], v[128:131], v[120:123], v[12:15]
v_mfma_f32_16x16x32_bf16 v[12:15], v[132:135], v[124:127], v[12:15]
Lb_mid:
s_waitcnt lgkmcnt(6)
v_mfma_f32_16x16x32_bf16 v[0:3], v[64:67], v[96:99], v[0:3]
ds_read_b64_tr_b16 v[108:109], v234 offset:24864
v_mfma_f32_16x16x32_bf16 v[0:3], v[68:71], v[100:103], v[0:3]
ds_read_b64_tr_b16 v[110:111], v234 offset:25376
v_mfma_f32_16x16x32_bf16 v[16:19], v[72:75], v[96:99], v[16:19]
ds_read_b64_tr_b16 v[112:113], v234 offset:16448
v_mfma_f32_16x16x32_bf16 v[16:19], v[76:79], v[100:103], v[16:19]
ds_read_b64_tr_b16 v[114:115], v234 offset:16960
s_waitcnt lgkmcnt(6)
v_mfma_f32_16x16x32_bf16 v[32:35], v[80:83], v[96:99], v[32:35]
ds_read_b64_tr_b16 v[116:117], v234 offset:24896
v_mfma_f32_16x16x32_bf16 v[32:35], v[84:87], v[100:103], v[32:35]
ds_read_b64_tr_b16 v[118:119], v234 offset:25408
v_mfma_f32_16x16x32_bf16 v[48:51], v[88:91], v[96:99], v[48:51]
ds_read_b64_tr_b16 v[120:121], v234 offset:16480
v_mfma_f32_16x16x32_bf16 v[48:51], v[92:95], v[100:103], v[48:51]
ds_read_b64_tr_b16 v[122:123], v234 offset:16992
s_waitcnt lgkmcnt(6)
v_mfma_f32_16x16x32_bf16 v[52:55], v[88:91], v[104:107], v[52:55]
ds_read_b64_tr_b16 v[124:125], v234 offset:24928
v_mfma_f32_16x16x32_bf16 v[52:55], v[92:95], v[108:111], v[52:55]
ds_read_b64_tr_b16 v[126:127], v234 offset:25440
v_mfma_f32_16x16x32_bf16 v[36:39], v[80:83], v[104:107], v[36:39]
v_mfma_f32_16x16x32_bf16 v[36:39], v[84:87], v[108:111], v[36:39]
v_mfma_f32_16x16x32_bf16 v[20:23], v[72:75], v[104:107], v[20:23]
v_mfma_f32_16x16x32_bf16 v[20:23], v[76:79], v[108:111], v[20:23]
v_mfma_f32_16x16x32_bf16 v[4:7], v[64:67], v[104:107], v[4:7]
v_mfma_f32_16x16x32_bf16 v[4:7], v[68:71], v[108:111], v[4:7]
s_waitcnt lgkmcnt(0)
s_barrier
v_mfma_f32_16x16x32_bf16 v[8:11], v[64:67], v[112:115], v[8:11]
ds_read_b64_tr_b16 v[96:97], v234 offset:49664
v_mfma_f32_16x16x32_bf16 v[8:11], v[68:71], v[116:119], v[8:11]
ds_read_b64_tr_b16 v[98:99], v234 offset:50176
v_mfma_f32_16x16x32_bf16 v[24:27], v[72:75], v[112:115], v[24:27]
ds_read_b64_tr_b16 v[100:101], v234 offset:58112
v_mfma_f32_16x16x32_bf16 v[24:27], v[76:79], v[116:119], v[24:27]
ds_read_b64_tr_b16 v[102:103], v234 offset:58624
v_mfma_f32_16x16x32_bf16 v[40:43], v[80:83], v[112:115], v[40:43]
ds_read_b128 v[128:131], v230 offset:33280
v_mfma_f32_16x16x32_bf16 v[40:43], v[84:87], v[116:119], v[40:43]
ds_read_b128 v[132:135], v231 offset:33280
v_mfma_f32_16x16x32_bf16 v[56:59], v[88:91], v[112:115], v[56:59]
ds_read_b128 v[136:139], v230 offset:35328
v_mfma_f32_16x16x32_bf16 v[56:59], v[92:95], v[116:119], v[56:59]
ds_read_b128 v[140:143], v231 offset:35328
v_mfma_f32_16x16x32_bf16 v[60:63], v[88:91], v[120:123], v[60:63]
ds_read_b128 v[144:147], v230 offset:37376
v_mfma_f32_16x16x32_bf16 v[60:63], v[92:95], v[124:127], v[60:63]
ds_read_b128 v[148:151], v231 offset:37376
v_mfma_f32_16x16x32_bf16 v[44:47], v[80:83], v[120:123], v[44:47]
ds_read_b128 v[152:155], v230 offset:39424
v_mfma_f32_16x16x32_bf16 v[44:47], v[84:87], v[124:127], v[44:47]
ds_read_b128 v[156:159], v231 offset:39424
v_mfma_f32_16x16x32_bf16 v[28:31], v[72:75], v[120:123], v[28:31]
ds_read_b64_tr_b16 v[104:105], v234 offset:49696
v_mfma_f32_16x16x32_bf16 v[28:31], v[76:79], v[124:127], v[28:31]
ds_read_b64_tr_b16 v[106:107], v234 offset:50208
v_mfma_f32_16x16x32_bf16 v[12:15], v[64:67], v[120:123], v[12:15]
v_mfma_f32_16x16x32_bf16 v[12:15], v[68:71], v[124:127], v[12:15]
s_waitcnt lgkmcnt(6)
v_mfma_f32_16x16x32_bf16 v[0:3], v[128:131], v[96:99], v[0:3]
ds_read_b64_tr_b16 v[108:109], v234 offset:58144
v_mfma_f32_16x16x32_bf16 v[0:3], v[132:135], v[100:103], v[0:3]
ds_read_b64_tr_b16 v[110:111], v234 offset:58656
v_mfma_f32_16x16x32_bf16 v[16:19], v[136:139], v[96:99], v[16:19]
ds_read_b64_tr_b16 v[112:113], v234 offset:49728
v_mfma_f32_16x16x32_bf16 v[16:19], v[140:143], v[100:103], v[16:19]
ds_read_b64_tr_b16 v[114:115], v234 offset:50240
s_waitcnt lgkmcnt(6)
v_mfma_f32_16x16x32_bf16 v[32:35], v[144:147], v[96:99], v[32:35]
ds_read_b64_tr_b16 v[116:117], v234 offset:58176
v_mfma_f32_16x16x32_bf16 v[32:35], v[148:151], v[100:103], v[32:35]
ds_read_b64_tr_b16 v[118:119], v234 offset:58688
v_mfma_f32_16x16x32_bf16 v[48:51], v[152:155], v[96:99], v[48:51]
ds_read_b64_tr_b16 v[120:121], v234 offset:49760
v_mfma_f32_16x16x32_bf16 v[48:51], v[156:159], v[100:103], v[48:51]
ds_read_b64_tr_b16 v[122:123], v234 offset:50272
s_waitcnt lgkmcnt(6)
v_mfma_f32_16x16x32_bf16 v[52:55], v[152:155], v[104:107], v[52:55]
ds_read_b64_tr_b16 v[124:125], v234 offset:58208
v_mfma_f32_16x16x32_bf16 v[52:55], v[156:159], v[108:111], v[52:55]
ds_read_b64_tr_b16 v[126:127], v234 offset:58720
v_mfma_f32_16x16x32_bf16 v[36:39], v[144:147], v[104:107], v[36:39]
v_mfma_f32_16x16x32_bf16 v[36:39], v[148:151], v[108:111], v[36:39]
v_mfma_f32_16x16x32_bf16 v[20:23], v[136:139], v[104:107], v[20:23]
v_mfma_f32_16x16x32_bf16 v[20:23], v[140:143], v[108:111], v[20:23]
v_mfma_f32_16x16x32_bf16 v[4:7], v[128:131], v[104:107], v[4:7]
v_mfma_f32_16x16x32_bf16 v[4:7], v[132:135], v[108:111], v[4:7]
s_waitcnt lgkmcnt(0)
s_barrier
v_mfma_f32_16x16x32_bf16 v[8:11], v[128:131], v[112:115], v[8:11]
ds_read_b64_tr_b16 v[96:97], v235 offset:16384
v_mfma_f32_16x16x32_bf16 v[8:11], v[132:135], v[116:119], v[8:11]
ds_read_b64_tr_b16 v[98:99], v235 offset:16896
v_mfma_f32_16x16x32_bf16 v[24:27], v[136:139], v[112:115], v[24:27]
ds_read_b64_tr_b16 v[100:101], v235 offset:24832
v_mfma_f32_16x16x32_bf16 v[24:27], v[140:143], v[116:119], v[24:27]
ds_read_b64_tr_b16 v[102:103], v235 offset:25344
v_mfma_f32_16x16x32_bf16 v[40:43], v[144:147], v[112:115], v[40:43]
ds_read_b128 v[64:67], v232 offset:0
v_mfma_f32_16x16x32_bf16 v[40:43], v[148:151], v[116:119], v[40:43]
ds_read_b128 v[68:71], v233 offset:0
v_mfma_f32_16x16x32_bf16 v[56:59], v[152:155], v[112:115], v[56:59]
ds_read_b128 v[72:75], v232 offset:2048
v_mfma_f32_16x16x32_bf16 v[56:59], v[156:159], v[116:119], v[56:59]
ds_read_b128 v[76:79], v233 offset:2048
v_mfma_f32_16x16x32_bf16 v[60:63], v[152:155], v[120:123], v[60:63]
ds_read_b128 v[80:83], v232 offset:4096
v_mfma_f32_16x16x32_bf16 v[60:63], v[156:159], v[124:127], v[60:63]
ds_read_b128 v[84:87], v233 offset:4096
v_mfma_f32_16x16x32_bf16 v[44:47], v[144:147], v[120:123], v[44:47]
ds_read_b128 v[88:91], v232 offset:6144
v_mfma_f32_16x16x32_bf16 v[44:47], v[148:151], v[124:127], v[44:47]
ds_read_b128 v[92:95], v233 offset:6144
v_mfma_f32_16x16x32_bf16 v[28:31], v[136:139], v[120:123], v[28:31]
ds_read_b64_tr_b16 v[104:105], v235 offset:16416
v_mfma_f32_16x16x32_bf16 v[28:31], v[140:143], v[124:127], v[28:31]
ds_read_b64_tr_b16 v[106:107], v235 offset:16928
v_mfma_f32_16x16x32_bf16 v[12:15], v[128:131], v[120:123], v[12:15]
v_mfma_f32_16x16x32_bf16 v[12:15], v[132:135], v[124:127], v[12:15]
s_waitcnt lgkmcnt(6)
v_mfma_f32_16x16x32_bf16 v[0:3], v[64:67], v[96:99], v[0:3]
ds_read_b64_tr_b16 v[108:109], v235 offset:24864
v_mfma_f32_16x16x32_bf16 v[0:3], v[68:71], v[100:103], v[0:3]
ds_read_b64_tr_b16 v[110:111], v235 offset:25376
v_mfma_f32_16x16x32_bf16 v[16:19], v[72:75], v[96:99], v[16:19]
ds_read_b64_tr_b16 v[112:113], v235 offset:16448
v_mfma_f32_16x16x32_bf16 v[16:19], v[76:79], v[100:103], v[16:19]
ds_read_b64_tr_b16 v[114:115], v235 offset:16960
s_waitcnt lgkmcnt(6)
v_mfma_f32_16x16x32_bf16 v[32:35], v[80:83], v[96:99], v[32:35]
ds_read_b64_tr_b16 v[116:117], v235 offset:24896
v_mfma_f32_16x16x32_bf16 v[32:35], v[84:87], v[100:103], v[32:35]
ds_read_b64_tr_b16 v[118:119], v235 offset:25408
v_mfma_f32_16x16x32_bf16 v[48:51], v[88:91], v[96:99], v[48:51]
ds_read_b64_tr_b16 v[120:121], v235 offset:16480
v_mfma_f32_16x16x32_bf16 v[48:51], v[92:95], v[100:103], v[48:51]
ds_read_b64_tr_b16 v[122:123], v235 offset:16992
s_waitcnt lgkmcnt(6)
v_mfma_f32_16x16x32_bf16 v[52:55], v[88:91], v[104:107], v[52:55]
ds_read_b64_tr_b16 v[124:125], v235 offset:24928
v_mfma_f32_16x16x32_bf16 v[52:55], v[92:95], v[108:111], v[52:55]
ds_read_b64_tr_b16 v[126:127], v235 offset:25440
v_mfma_f32_16x16x32_bf16 v[36:39], v[80:83], v[104:107], v[36:39]
v_mfma_f32_16x16x32_bf16 v[36:39], v[84:87], v[108:111], v[36:39]
v_mfma_f32_16x16x32_bf16 v[20:23], v[72:75], v[104:107], v[20:23]
v_mfma_f32_16x16x32_bf16 v[20:23], v[76:79], v[108:111], v[20:23]
v_mfma_f32_16x16x32_bf16 v[4:7], v[64:67], v[104:107], v[4:7]
v_mfma_f32_16x16x32_bf16 v[4:7], v[68:71], v[108:111], v[4:7]
s_waitcnt lgkmcnt(0)
s_barrier
v_mfma_f32_16x16x32_bf16 v[8:11], v[64:67], v[112:115], v[8:11]
ds_read_b64_tr_b16 v[96:97], v235 offset:49664
v_mfma_f32_16x16x32_bf16 v[8:11], v[68:71], v[116:119], v[8:11]
ds_read_b64_tr_b16 v[98:99], v235 offset:50176
v_mfma_f32_16x16x32_bf16 v[24:27], v[72:75], v[112:115], v[24:27]
ds_read_b64_tr_b16 v[100:101], v235 offset:58112
v_mfma_f32_16x16x32_bf16 v[24:27], v[76:79], v[116:119], v[24:27]
ds_read_b64_tr_b16 v[102:103], v235 offset:58624
v_mfma_f32_16x16x32_bf16 v[40:43], v[80:83], v[112:115], v[40:43]
ds_read_b128 v[128:131], v232 offset:33280
v_mfma_f32_16x16x32_bf16 v[40:43], v[84:87], v[116:119], v[40:43]
ds_read_b128 v[132:135], v233 offset:33280
v_mfma_f32_16x16x32_bf16 v[56:59], v[88:91], v[112:115], v[56:59]
ds_read_b128 v[136:139], v232 offset:35328
v_mfma_f32_16x16x32_bf16 v[56:59], v[92:95], v[116:119], v[56:59]
ds_read_b128 v[140:143], v233 offset:35328
v_mfma_f32_16x16x32_bf16 v[60:63], v[88:91], v[120:123], v[60:63]
ds_read_b128 v[144:147], v232 offset:37376
v_mfma_f32_16x16x32_bf16 v[60:63], v[92:95], v[124:127], v[60:63]
ds_read_b128 v[148:151], v233 offset:37376
v_mfma_f32_16x16x32_bf16 v[44:47], v[80:83], v[120:123], v[44:47]
ds_read_b128 v[152:155], v232 offset:39424
v_mfma_f32_16x16x32_bf16 v[44:47], v[84:87], v[124:127], v[44:47]
ds_read_b128 v[156:159], v233 offset:39424
v_mfma_f32_16x16x32_bf16 v[28:31], v[72:75], v[120:123], v[28:31]
ds_read_b64_tr_b16 v[104:105], v235 offset:49696
v_mfma_f32_16x16x32_bf16 v[28:31], v[76:79], v[124:127], v[28:31]
ds_read_b64_tr_b16 v[106:107], v235 offset:50208
v_mfma_f32_16x16x32_bf16 v[12:15], v[64:67], v[120:123], v[12:15]
v_mfma_f32_16x16x32_bf16 v[12:15], v[68:71], v[124:127], v[12:15]
s_waitcnt lgkmcnt(6)
v_mfma_f32_16x16x32_bf16 v[0:3], v[128:131], v[96:99], v[0:3]
ds_read_b64_tr_b16 v[108:109], v235 offset:58144
v_mfma_f32_16x16x32_bf16 v[0:3], v[132:135], v[100:103], v[0:3]
ds_read_b64_tr_b16 v[110:111], v235 offset:58656
v_mfma_f32_16x16x32_bf16 v[16:19], v[136:139], v[96:99], v[16:19]
ds_read_b64_tr_b16 v[112:113], v235 offset:49728
v_mfma_f32_16x16x32_bf16 v[16:19], v[140:143], v[100:103], v[16:19]
ds_read_b64_tr_b16 v[114:115], v235 offset:50240
s_waitcnt lgkmcnt(6)
v_mfma_f32_16x16x32_bf16 v[32:35], v[144:147], v[96:99], v[32:35]
ds_read_b64_tr_b16 v[116:117], v235 offset:58176
v_mfma_f32_16x16x32_bf16 v[32:35], v[148:151], v[100:103], v[32:35]
ds_read_b64_tr_b16 v[118:119], v235 offset:58688
v_mfma_f32_16x16x32_bf16 v[48:51], v[152:155], v[96:99], v[48:51]
ds_read_b64_tr_b16 v[120:121], v235 offset:49760
v_mfma_f32_16x16x32_bf16 v[48:51], v[156:159], v[100:103], v[48:51]
ds_read_b64_tr_b16 v[122:123], v235 offset:50272
s_waitcnt lgkmcnt(6)
v_mfma_f32_16x16x32_bf16 v[52:55], v[152:155], v[104:107], v[52:55]
ds_read_b64_tr_b16 v[124:125], v235 offset:58208
v_mfma_f32_16x16x32_bf16 v[52:55], v[156:159], v[108:111], v[52:55]
ds_read_b64_tr_b16 v[126:127], v235 offset:58720
v_mfma_f32_16x16x32_bf16 v[36:39], v[144:147], v[104:107], v[36:39]
v_mfma_f32_16x16x32_bf16 v[36:39], v[148:151], v[108:111], v[36:39]
v_mfma_f32_16x16x32_bf16 v[20:23], v[136:139], v[104:107], v[20:23]
v_mfma_f32_16x16x32_bf16 v[20:23], v[140:143], v[108:111], v[20:23]
s_sub_u32 s23, s23, 1
v_mfma_f32_16x16x32_bf16 v[4:7], v[128:131], v[104:107], v[4:7]
s_cmp_lg_u32 s23, 0
v_mfma_f32_16x16x32_bf16 v[4:7], v[132:135], v[108:111], v[4:7]
s_waitcnt vmcnt(0) lgkmcnt(0)
s_cbranch_scc1 Lb_loop
s_barrier
v_mfma_f32_16x16x32_bf16 v[8:11], v[128:131], v[112:115], v[8:11]
v_cvt_pk_bf16_f32 v160, v0, v1
v_cvt_pk_bf16_f32 v161, v2, v3
v_mfma_f32_16x16x32_bf16 v[8:11], v[132:135], v[116:119], v[8:11]
v_cvt_pk_bf16_f32 v162, v16, v17
v_cvt_pk_bf16_f32 v163, v18, v19
v_mfma_f32_16x16x32_bf16 v[24:27], v[136:139], v[112:115], v[24:27]
buffer_store_dwordx4 v[160:163], v248, s[16:19], s24 offen offset:0 sc1
v_mfma_f32_16x16x32_bf16 v[24:27], v[140:143], v[116:119], v[24:27]
ds_write_b128 v228, v[160:163] offset:0
v_mfma_f32_16x16x32_bf16 v[40:43], v[144:147], v[112:115], v[40:43]
v_cvt_pk_bf16_f32 v176, v32, v33
v_cvt_pk_bf16_f32 v177, v34, v35
v_mfma_f32_16x16x32_bf16 v[40:43], v[148:151], v[116:119], v[40:43]
v_cvt_pk_bf16_f32 v178, v48, v49
v_cvt_pk_bf16_f32 v179, v50, v51
v_mfma_f32_16x16x32_bf16 v[56:59], v[152:155], v[112:115], v[56:59]
buffer_store_dwordx4 v[176:179], v248, s[16:19], s26 offen offset:0 sc1
v_mfma_f32_16x16x32_bf16 v[56:59], v[156:159], v[116:119], v[56:59]
ds_write_b128 v228, v[176:179] offset:8320
v_mfma_f32_16x16x32_bf16 v[60:63], v[152:155], v[120:123], v[60:63]
v_cvt_pk_bf16_f32 v180, v36, v37
v_cvt_pk_bf16_f32 v181, v38, v39
v_mfma_f32_16x16x32_bf16 v[60:63], v[156:159], v[124:127], v[60:63]
v_cvt_pk_bf16_f32 v182, v52, v53
v_cvt_pk_bf16_f32 v183, v54, v55
v_mfma_f32_16x16x32_bf16 v[44:47], v[144:147], v[120:123], v[44:47]
buffer_store_dwordx4 v[180:183], v248, s[16:19], s26 offen offset:1024 sc1
v_mfma_f32_16x16x32_bf16 v[44:47], v[148:151], v[124:127], v[44:47]
ds_write_b128 v228, v[180:183] offset:9360
v_mfma_f32_16x16x32_bf16 v[28:31], v[136:139], v[120:123], v[28:31]
v_cvt_pk_bf16_f32 v164, v4, v5
v_cvt_pk_bf16_f32 v165, v6, v7
v_mfma_f32_16x16x32_bf16 v[28:31], v[140:143], v[124:127], v[28:31]
v_cvt_pk_bf16_f32 v166, v20, v21
v_cvt_pk_bf16_f32 v167, v22, v23
v_mfma_f32_16x16x32_bf16 v[12:15], v[128:131], v[120:123], v[12:15]
buffer_store_dwordx4 v[164:167], v248, s[16:19], s24 offen offset:1024 sc1
v_mfma_f32_16x16x32_bf16 v[12:15], v[132:135], v[124:127], v[12:15]
ds_write_b128 v228, v[164:167] offset:1040
v_cvt_pk_bf16_f32 v168, v8, v9
v_cvt_pk_bf16_f32 v169, v10, v11
v_cvt_pk_bf16_f32 v170, v24, v25
v_cvt_pk_bf16_f32 v171, v26, v27
buffer_store_dwordx4 v[168:171], v248, s[16:19], s24 offen offset:2048 sc1
v_cvt_pk_bf16_f32 v184, v40, v41
v_cvt_pk_bf16_f32 v185, v42, v43
v_cvt_pk_bf16_f32 v186, v56, v57
v_cvt_pk_bf16_f32 v187, v58, v59
buffer_store_dwordx4 v[184:187], v248, s[16:19], s26 offen offset:2048 sc1
v_cvt_pk_bf16_f32 v188, v44, v45
v_cvt_pk_bf16_f32 v189, v46, v47
v_cvt_pk_bf16_f32 v190, v60, v61
v_cvt_pk_bf16_f32 v191, v62, v63
buffer_store_dwordx4 v[188:191], v248, s[16:19], s26 offen offset:3072 sc1
v_cvt_pk_bf16_f32 v172, v12, v13
v_cvt_pk_bf16_f32 v173, v14, v15
v_cvt_pk_bf16_f32 v174, v28, v29
v_cvt_pk_bf16_f32 v175, v30, v31
buffer_store_dwordx4 v[172:175], v248, s[16:19], s24 offen offset:3072 sc1
ds_write_b128 v228, v[168:171] offset:2080
ds_write_b128 v228, v[184:187] offset:10400
ds_write_b128 v228, v[188:191] offset:11440
ds_write_b128 v228, v[172:175] offset:3120
s_mov_b32 s16, s48
s_mov_b32 s17, s49
s_mov_b32 s18, 14680064
s_mov_b32 s19, 0x20000
s_lshl_b32 s34, s33, 8
s_mul_i32 s24, s25, 458752
s_add_u32 s24, s24, s34
s_waitcnt lgkmcnt(0)
s_barrier
ds_read_b128 v[128:131], v224 offset:0
ds_read_b128 v[132:135], v224 offset:16384
ds_read_b128 v[160:163], v227 offset:0
ds_read_b128 v[164:167], v227 offset:8320
ds_read_b128 v[168:171], v227 offset:16
ds_read_b128 v[172:175], v227 offset:8336
ds_read_b128 v[176:179], v227 offset:32
ds_read_b128 v[180:183], v227 offset:8352
ds_read_b128 v[184:187], v227 offset:48
ds_read_b128 v[188:191], v227 offset:8368
ds_read_b128 v[136:139], v224 offset:1024
ds_read_b128 v[140:143], v224 offset:17408
ds_read_b128 v[144:147], v224 offset:2048
ds_read_b128 v[148:151], v224 offset:18432
s_mov_b32 s23, 4
s_waitcnt lgkmcnt(10)
v_mfma_f32_16x16x32_bf16 v[0:3], v[128:131], v[160:163], 0
ds_read_b128 v[152:155], v224 offset:3072
v_mfma_f32_16x16x32_bf16 v[0:3], v[132:135], v[164:167], v[0:3]
ds_read_b128 v[156:159], v224 offset:19456
s_waitcnt lgkmcnt(10)
v_mfma_f32_16x16x32_bf16 v[4:7], v[128:131], v[168:171], 0
ds_read_b128 v[192:195], v227 offset:64
v_mfma_f32_16x16x32_bf16 v[4:7], v[132:135], v[172:175], v[4:7]
ds_read_b128 v[196:199], v227 offset:8384
s_waitcnt lgkmcnt(10)
v_mfma_f32_16x16x32_bf16 v[8:11], v[128:131], v[176:179], 0
ds_read_b128 v[200:203], v227 offset:80
v_mfma_f32_16x16x32_bf16 v[8:11], v[132:135], v[180:183], v[8:11]
ds_read_b128 v[204:207], v227 offset:8400
s_waitcnt lgkmcnt(10)
v_mfma_f32_16x16x32_bf16 v[12:15], v[128:131], v[184:187], 0
ds_read_b128 v[208:211], v227 offset:96
v_mfma_f32_16x16x32_bf16 v[12:15], v[132:135], v[188:191], v[12:15]
ds_read_b128 v[212:215], v227 offset:8416
s_waitcnt lgkmcnt(10)
v_mfma_f32_16x16x32_bf16 v[44:47], v[136:139], v[184:187], 0
ds_read_b128 v[216:219], v227 offset:112
v_mfma_f32_16x16x32_bf16 v[44:47], v[140:143], v[188:191], v[44:47]
ds_read_b128 v[220:223], v227 offset:8432
v_mfma_f32_16x16x32_bf16 v[40:43], v[136:139], v[176:179], 0
v_mov_b32 v16, 0
v_mov_b32 v17, 0
v_mov_b32 v18, 0
v_mfma_f32_16x16x32_bf16 v[40:43], v[140:143], v[180:183], v[40:43]
v_mov_b32 v19, 0
v_mov_b32 v20, 0
v_mov_b32 v21, 0
v_mfma_f32_16x16x32_bf16 v[36:39], v[136:139], v[168:171], 0
v_mov_b32 v22, 0
v_mov_b32 v23, 0
v_mov_b32 v24, 0
v_mfma_f32_16x16x32_bf16 v[36:39], v[140:143], v[172:175], v[36:39]
v_mov_b32 v25, 0
v_mov_b32 v26, 0
v_mov_b32 v27, 0
v_mfma_f32_16x16x32_bf16 v[32:35], v[136:139], v[160:163], 0
v_mov_b32 v28, 0
v_mov_b32 v29, 0
v_mov_b32 v30, 0
v_mfma_f32_16x16x32_bf16 v[32:35], v[140:143], v[164:167], v[32:35]
v_mov_b32 v31, 0
v_mov_b32 v48, 0
v_mov_b32 v49, 0
s_waitcnt lgkmcnt(10)
v_mfma_f32_16x16x32_bf16 v[64:67], v[144:147], v[160:163], 0
v_mov_b32 v50, 0
v_mov_b32 v51, 0
v_mov_b32 v52, 0
v_mfma_f32_16x16x32_bf16 v[64:67], v[148:151], v[164:167], v[64:67]
v_mov_b32 v53, 0
v_mov_b32 v54, 0
v_mov_b32 v55, 0
v_mfma_f32_16x16x32_bf16 v[68:71], v[144:147], v[168:171], 0
v_mov_b32 v56, 0
v_mov_b32 v57, 0
v_mov_b32 v58, 0
v_mfma_f32_16x16x32_bf16 v[68:71], v[148:151], v[172:175], v[68:71]
v_mov_b32 v59, 0
v_mov_b32 v60, 0
v_mov_b32 v61, 0
v_mfma_f32_16x16x32_bf16 v[72:75], v[144:147], v[176:179], 0
v_mov_b32 v62, 0
v_mov_b32 v63, 0
v_mov_b32 v80, 0
v_mfma_f32_16x16x32_bf16 v[72:75], v[148:151], v[180:183], v[72:75]
v_mov_b32 v81, 0
v_mov_b32 v82, 0
v_mov_b32 v83, 0
v_mfma_f32_16x16x32_bf16 v[76:79], v[144:147], v[184:187], 0
v_mov_b32 v84, 0
v_mov_b32 v85, 0
v_mov_b32 v86, 0
v_mfma_f32_16x16x32_bf16 v[76:79], v[148:151], v[188:191], v[76:79]
v_mov_b32 v87, 0
v_mov_b32 v88, 0
v_mov_b32 v89, 0
s_waitcnt lgkmcnt(8)
v_mfma_f32_16x16x32_bf16 v[108:111], v[152:155], v[184:187], 0
v_mov_b32 v90, 0
v_mov_b32 v91, 0
v_mov_b32 v92, 0
v_mfma_f32_16x16x32_bf16 v[108:111], v[156:159], v[188:191], v[108:111]
v_mov_b32 v93, 0
v_mov_b32 v94, 0
v_mov_b32 v95, 0
v_mfma_f32_16x16x32_bf16 v[104:107], v[152:155], v[176:179], 0
v_mov_b32 v112, 0
v_mov_b32 v113, 0
v_mov_b32 v114, 0
v_mfma_f32_16x16x32_bf16 v[104:107], v[156:159], v[180:183], v[104:107]
v_mov_b32 v115, 0
v_mov_b32 v116, 0
v_mov_b32 v117, 0
v_mfma_f32_16x16x32_bf16 v[100:103], v[152:155], v[168:171], 0
v_mov_b32 v118, 0
v_mov_b32 v119, 0
v_mov_b32 v120, 0
v_mfma_f32_16x16x32_bf16 v[100:103], v[156:159], v[172:175], v[100:103]
v_mov_b32 v121, 0
v_mov_b32 v122, 0
v_mov_b32 v123, 0
v_mfma_f32_16x16x32_bf16 v[96:99], v[152:155], v[160:163], 0
v_mov_b32 v124, 0
v_mov_b32 v125, 0
v_mov_b32 v126, 0
v_mfma_f32_16x16x32_bf16 v[96:99], v[156:159], v[164:167], v[96:99]
v_mov_b32 v127, 0
s_waitcnt vmcnt(0) lgkmcnt(0)
s_barrier
Lc_loop:
v_mfma_f32_16x16x32_bf16 v[16:19], v[128:131], v[192:195], v[16:19]
ds_read_b128 v[160:163], v227 offset:16640
v_mfma_f32_16x16x32_bf16 v[16:19], v[132:135], v[196:199], v[16:19]
v_mfma_f32_16x16x32_bf16 v[20:23], v[128:131], v[200:203], v[20:23]
ds_read_b128 v[164:167], v227 offset:24960
v_mfma_f32_16x16x32_bf16 v[20:23], v[132:135], v[204:207], v[20:23]
v_mfma_f32_16x16x32_bf16 v[24:27], v[128:131], v[208:211], v[24:27]
ds_read_b128 v[168:171], v227 offset:16656
v_mfma_f32_16x16x32_bf16 v[24:27], v[132:135], v[212:215], v[24:27]
v_mfma_f32_16x16x32_bf16 v[28:31], v[128:131], v[216:219], v[28:31]
ds_read_b128 v[172:175], v227 offset:24976
v_mfma_f32_16x16x32_bf16 v[28:31], v[132:135], v[220:223], v[28:31]
v_mfma_f32_16x16x32_bf16 v[60:63], v[136:139], v[216:219], v[60:63]
ds_read_b128 v[128:131], v225 offset:0
v_mfma_f32_16x16x32_bf16 v[60:63], v[140:143], v[220:223], v[60:63]
v_mfma_f32_16x16x32_bf16 v[56:59], v[136:139], v[208:211], v[56:59]
ds_read_b128 v[132:135], v225 offset:16384
v_mfma_f32_16x16x32_bf16 v[56:59], v[140:143], v[212:215], v[56:59]
v_mfma_f32_16x16x32_bf16 v[52:55], v[136:139], v[200:203], v[52:55]
ds_read_b128 v[176:179], v227 offset:16672
v_mfma_f32_16x16x32_bf16 v[52:55], v[140:143], v[204:207], v[52:55]
v_mfma_f32_16x16x32_bf16 v[48:51], v[136:139], v[192:195], v[48:51]
ds_read_b128 v[180:183], v227 offset:24992
v_mfma_f32_16x16x32_bf16 v[48:51], v[140:143], v[196:199], v[48:51]
v_mfma_f32_16x16x32_bf16 v[80:83], v[144:147], v[192:195], v[80:83]
ds_read_b128 v[184:187], v227 offset:16688
v_mfma_f32_16x16x32_bf16 v[80:83], v[148:151], v[196:199], v[80:83]
v_mfma_f32_16x16x32_bf16 v[84:87], v[144:147], v[200:203], v[84:87]
ds_read_b128 v[188:191], v227 offset:25008
v_mfma_f32_16x16x32_bf16 v[84:87], v[148:151], v[204:207], v[84:87]
v_mfma_f32_16x16x32_bf16 v[88:91], v[144:147], v[208:211], v[88:91]
ds_read_b128 v[136:139], v225 offset:1024
v_mfma_f32_16x16x32_bf16 v[88:91], v[148:151], v[212:215], v[88:91]
v_mfma_f32_16x16x32_bf16 v[92:95], v[144:147], v[216:219], v[92:95]
ds_read_b128 v[140:143], v225 offset:17408
v_mfma_f32_16x16x32_bf16 v[92:95], v[148:151], v[220:223], v[92:95]
v_mfma_f32_16x16x32_bf16 v[124:127], v[152:155], v[216:219], v[124:127]
ds_read_b128 v[144:147], v225 offset:2048
v_mfma_f32_16x16x32_bf16 v[124:127], v[156:159], v[220:223], v[124:127]
v_mfma_f32_16x16x32_bf16 v[120:123], v[152:155], v[208:211], v[120:123]
ds_read_b128 v[148:151], v225 offset:18432
v_mfma_f32_16x16x32_bf16 v[120:123], v[156:159], v[212:215], v[120:123]
v_mfma_f32_16x16x32_bf16 v[116:119], v[152:155], v[200:203], v[116:119]
v_mfma_f32_16x16x32_bf16 v[116:119], v[156:159], v[204:207], v[116:119]
v_mfma_f32_16x16x32_bf16 v[112:115], v[152:155], v[192:195], v[112:115]
v_mfma_f32_16x16x32_bf16 v[112:115], v[156:159], v[196:199], v[112:115]
s_waitcnt lgkmcnt(4)
v_mfma_f32_16x16x32_bf16 v[0:3], v[128:131], v[160:163], v[0:3]
ds_read_b128 v[152:155], v225 offset:3072
v_mfma_f32_16x16x32_bf16 v[0:3], v[132:135], v[164:167], v[0:3]
v_mfma_f32_16x16x32_bf16 v[4:7], v[128:131], v[168:171], v[4:7]
ds_read_b128 v[156:159], v225 offset:19456
v_mfma_f32_16x16x32_bf16 v[4:7], v[132:135], v[172:175], v[4:7]
v_mfma_f32_16x16x32_bf16 v[8:11], v[128:131], v[176:179], v[8:11]
ds_read_b128 v[192:195], v227 offset:16704
v_mfma_f32_16x16x32_bf16 v[8:11], v[132:135], v[180:183], v[8:11]
v_mfma_f32_16x16x32_bf16 v[12:15], v[128:131], v[184:187], v[12:15]
ds_read_b128 v[196:199], v227 offset:25024
v_mfma_f32_16x16x32_bf16 v[12:15], v[132:135], v[188:191], v[12:15]
s_waitcnt lgkmcnt(6)
v_mfma_f32_16x16x32_bf16 v[44:47], v[136:139], v[184:187], v[44:47]
ds_read_b128 v[200:203], v227 offset:16720
v_mfma_f32_16x16x32_bf16 v[44:47], v[140:143], v[188:191], v[44:47]
v_mfma_f32_16x16x32_bf16 v[40:43], v[136:139], v[176:179], v[40:43]
ds_read_b128 v[204:207], v227 offset:25040
v_mfma_f32_16x16x32_bf16 v[40:43], v[140:143], v[180:183], v[40:43]
v_mfma_f32_16x16x32_bf16 v[36:39], v[136:139], v[168:171], v[36:39]
ds_read_b128 v[208:211], v227 offset:16736
v_mfma_f32_16x16x32_bf16 v[36:39], v[140:143], v[172:175], v[36:39]
v_mfma_f32_16x16x32_bf16 v[32:35], v[136:139], v[160:163], v[32:35]
ds_read_b128 v[212:215], v227 offset:25056
v_mfma_f32_16x16x32_bf16 v[32:35], v[140:143], v[164:167], v[32:35]
s_waitcnt lgkmcnt(8)
v_mfma_f32_16x16x32_bf16 v[64:67], v[144:147], v[160:163], v[64:67]
ds_read_b128 v[216:219], v227 offset:16752
v_mfma_f32_16x16x32_bf16 v[64:67], v[148:151], v[164:167], v[64:67]
v_mfma_f32_16x16x32_bf16 v[68:71], v[144:147], v[168:171], v[68:71]
ds_read_b128 v[220:223], v227 offset:25072
v_mfma_f32_16x16x32_bf16 v[68:71], v[148:151], v[172:175], v[68:71]
v_mfma_f32_16x16x32_bf16 v[72:75], v[144:147], v[176:179], v[72:75]
v_mfma_f32_16x16x32_bf16 v[72:75], v[148:151], v[180:183], v[72:75]
v_mfma_f32_16x16x32_bf16 v[76:79], v[144:147], v[184:187], v[76:79]
v_mfma_f32_16x16x32_bf16 v[76:79], v[148:151], v[188:191], v[76:79]
s_cmp_eq_u32 s23, 4
s_waitcnt lgkmcnt(8)
v_mfma_f32_16x16x32_bf16 v[108:111], v[152:155], v[184:187], v[108:111]
v_mfma_f32_16x16x32_bf16 v[108:111], v[156:159], v[188:191], v[108:111]
v_mfma_f32_16x16x32_bf16 v[104:107], v[152:155], v[176:179], v[104:107]
v_mfma_f32_16x16x32_bf16 v[104:107], v[156:159], v[180:183], v[104:107]
v_mfma_f32_16x16x32_bf16 v[100:103], v[152:155], v[168:171], v[100:103]
s_waitcnt lgkmcnt(0)
v_mfma_f32_16x16x32_bf16 v[100:103], v[156:159], v[172:175], v[100:103]
s_cbranch_scc1 Lc_peel
s_barrier
v_mfma_f32_16x16x32_bf16 v[96:99], v[152:155], v[160:163], v[96:99]
v_mfma_f32_16x16x32_bf16 v[96:99], v[156:159], v[164:167], v[96:99]
v_mfma_f32_16x16x32_bf16 v[16:19], v[128:131], v[192:195], v[16:19]
ds_read_b128 v[160:163], v227 offset:33280
v_mfma_f32_16x16x32_bf16 v[16:19], v[132:135], v[196:199], v[16:19]
v_mfma_f32_16x16x32_bf16 v[20:23], v[128:131], v[200:203], v[20:23]
ds_read_b128 v[164:167], v227 offset:41600
v_mfma_f32_16x16x32_bf16 v[20:23], v[132:135], v[204:207], v[20:23]
v_mfma_f32_16x16x32_bf16 v[24:27], v[128:131], v[208:211], v[24:27]
ds_read_b128 v[168:171], v227 offset:33296
v_mfma_f32_16x16x32_bf16 v[24:27], v[132:135], v[212:215], v[24:27]
v_mfma_f32_16x16x32_bf16 v[28:31], v[128:131], v[216:219], v[28:31]
ds_read_b128 v[172:175], v227 offset:41616
v_mfma_f32_16x16x32_bf16 v[28:31], v[132:135], v[220:223], v[28:31]
v_mfma_f32_16x16x32_bf16 v[60:63], v[136:139], v[216:219], v[60:63]
ds_read_b128 v[128:131], v226 offset:0
v_mfma_f32_16x16x32_bf16 v[60:63], v[140:143], v[220:223], v[60:63]
v_mfma_f32_16x16x32_bf16 v[56:59], v[136:139], v[208:211], v[56:59]
ds_read_b128 v[132:135], v226 offset:16384
v_mfma_f32_16x16x32_bf16 v[56:59], v[140:143], v[212:215], v[56:59]
v_mfma_f32_16x16x32_bf16 v[52:55], v[136:139], v[200:203], v[52:55]
ds_read_b128 v[176:179], v227 offset:33312
v_mfma_f32_16x16x32_bf16 v[52:55], v[140:143], v[204:207], v[52:55]
v_mfma_f32_16x16x32_bf16 v[48:51], v[136:139], v[192:195], v[48:51]
ds_read_b128 v[180:183], v227 offset:41632
v_mfma_f32_16x16x32_bf16 v[48:51], v[140:143], v[196:199], v[48:51]
v_mfma_f32_16x16x32_bf16 v[80:83], v[144:147], v[192:195], v[80:83]
ds_read_b128 v[184:187], v227 offset:33328
v_mfma_f32_16x16x32_bf16 v[80:83], v[148:151], v[196:199], v[80:83]
v_mfma_f32_16x16x32_bf16 v[84:87], v[144:147], v[200:203], v[84:87]
ds_read_b128 v[188:191], v227 offset:41648
v_mfma_f32_16x16x32_bf16 v[84:87], v[148:151], v[204:207], v[84:87]
v_mfma_f32_16x16x32_bf16 v[88:91], v[144:147], v[208:211], v[88:91]
ds_read_b128 v[136:139], v226 offset:1024
v_mfma_f32_16x16x32_bf16 v[88:91], v[148:151], v[212:215], v[88:91]
v_mfma_f32_16x16x32_bf16 v[92:95], v[144:147], v[216:219], v[92:95]
ds_read_b128 v[140:143], v226 offset:17408
v_mfma_f32_16x16x32_bf16 v[92:95], v[148:151], v[220:223], v[92:95]
v_mfma_f32_16x16x32_bf16 v[124:127], v[152:155], v[216:219], v[124:127]
ds_read_b128 v[144:147], v226 offset:2048
v_mfma_f32_16x16x32_bf16 v[124:127], v[156:159], v[220:223], v[124:127]
v_mfma_f32_16x16x32_bf16 v[120:123], v[152:155], v[208:211], v[120:123]
ds_read_b128 v[148:151], v226 offset:18432
v_mfma_f32_16x16x32_bf16 v[120:123], v[156:159], v[212:215], v[120:123]
v_mfma_f32_16x16x32_bf16 v[116:119], v[152:155], v[200:203], v[116:119]
v_mfma_f32_16x16x32_bf16 v[116:119], v[156:159], v[204:207], v[116:119]
v_mfma_f32_16x16x32_bf16 v[112:115], v[152:155], v[192:195], v[112:115]
v_mfma_f32_16x16x32_bf16 v[112:115], v[156:159], v[196:199], v[112:115]
Lc_mid:
s_waitcnt lgkmcnt(4)
v_mfma_f32_16x16x32_bf16 v[0:3], v[128:131], v[160:163], v[0:3]
ds_read_b128 v[152:155], v226 offset:3072
v_mfma_f32_16x16x32_bf16 v[0:3], v[132:135], v[164:167], v[0:3]
v_mfma_f32_16x16x32_bf16 v[4:7], v[128:131], v[168:171], v[4:7]
ds_read_b128 v[156:159], v226 offset:19456
v_mfma_f32_16x16x32_bf16 v[4:7], v[132:135], v[172:175], v[4:7]
v_mfma_f32_16x16x32_bf16 v[8:11], v[128:131], v[176:179], v[8:11]
ds_read_b128 v[192:195], v227 offset:33344
v_mfma_f32_16x16x32_bf16 v[8:11], v[132:135], v[180:183], v[8:11]
v_mfma_f32_16x16x32_bf16 v[12:15], v[128:131], v[184:187], v[12:15]
ds_read_b128 v[196:199], v227 offset:41664
v_mfma_f32_16x16x32_bf16 v[12:15], v[132:135], v[188:191], v[12:15]
s_waitcnt lgkmcnt(6)
v_mfma_f32_16x16x32_bf16 v[44:47], v[136:139], v[184:187], v[44:47]
ds_read_b128 v[200:203], v227 offset:33360
v_mfma_f32_16x16x32_bf16 v[44:47], v[140:143], v[188:191], v[44:47]
v_mfma_f32_16x16x32_bf16 v[40:43], v[136:139], v[176:179], v[40:43]
ds_read_b128 v[204:207], v227 offset:41680
v_mfma_f32_16x16x32_bf16 v[40:43], v[140:143], v[180:183], v[40:43]
v_mfma_f32_16x16x32_bf16 v[36:39], v[136:139], v[168:171], v[36:39]
ds_read_b128 v[208:211], v227 offset:33376
v_mfma_f32_16x16x32_bf16 v[36:39], v[140:143], v[172:175], v[36:39]
v_mfma_f32_16x16x32_bf16 v[32:35], v[136:139], v[160:163], v[32:35]
ds_read_b128 v[212:215], v227 offset:41696
v_mfma_f32_16x16x32_bf16 v[32:35], v[140:143], v[164:167], v[32:35]
s_waitcnt lgkmcnt(8)
v_mfma_f32_16x16x32_bf16 v[64:67], v[144:147], v[160:163], v[64:67]
ds_read_b128 v[216:219], v227 offset:33392
v_mfma_f32_16x16x32_bf16 v[64:67], v[148:151], v[164:167], v[64:67]
v_mfma_f32_16x16x32_bf16 v[68:71], v[144:147], v[168:171], v[68:71]
ds_read_b128 v[220:223], v227 offset:41712
v_mfma_f32_16x16x32_bf16 v[68:71], v[148:151], v[172:175], v[68:71]
v_mfma_f32_16x16x32_bf16 v[72:75], v[144:147], v[176:179], v[72:75]
v_mfma_f32_16x16x32_bf16 v[72:75], v[148:151], v[180:183], v[72:75]
v_mfma_f32_16x16x32_bf16 v[76:79], v[144:147], v[184:187], v[76:79]
v_mfma_f32_16x16x32_bf16 v[76:79], v[148:151], v[188:191], v[76:79]
s_waitcnt lgkmcnt(8)
v_mfma_f32_16x16x32_bf16 v[108:111], v[152:155], v[184:187], v[108:111]
v_mfma_f32_16x16x32_bf16 v[108:111], v[156:159], v[188:191], v[108:111]
v_mfma_f32_16x16x32_bf16 v[104:107], v[152:155], v[176:179], v[104:107]
v_mfma_f32_16x16x32_bf16 v[104:107], v[156:159], v[180:183], v[104:107]
v_mfma_f32_16x16x32_bf16 v[100:103], v[152:155], v[168:171], v[100:103]
s_waitcnt lgkmcnt(0)
v_mfma_f32_16x16x32_bf16 v[100:103], v[156:159], v[172:175], v[100:103]
s_barrier
v_mfma_f32_16x16x32_bf16 v[96:99], v[152:155], v[160:163], v[96:99]
v_mfma_f32_16x16x32_bf16 v[96:99], v[156:159], v[164:167], v[96:99]
v_mfma_f32_16x16x32_bf16 v[16:19], v[128:131], v[192:195], v[16:19]
ds_read_b128 v[160:163], v227 offset:0
v_mfma_f32_16x16x32_bf16 v[16:19], v[132:135], v[196:199], v[16:19]
v_mfma_f32_16x16x32_bf16 v[20:23], v[128:131], v[200:203], v[20:23]
ds_read_b128 v[164:167], v227 offset:8320
v_mfma_f32_16x16x32_bf16 v[20:23], v[132:135], v[204:207], v[20:23]
v_mfma_f32_16x16x32_bf16 v[24:27], v[128:131], v[208:211], v[24:27]
ds_read_b128 v[168:171], v227 offset:16
v_mfma_f32_16x16x32_bf16 v[24:27], v[132:135], v[212:215], v[24:27]
v_mfma_f32_16x16x32_bf16 v[28:31], v[128:131], v[216:219], v[28:31]
ds_read_b128 v[172:175], v227 offset:8336
v_mfma_f32_16x16x32_bf16 v[28:31], v[132:135], v[220:223], v[28:31]
v_mfma_f32_16x16x32_bf16 v[60:63], v[136:139], v[216:219], v[60:63]
ds_read_b128 v[128:131], v224 offset:0
v_mfma_f32_16x16x32_bf16 v[60:63], v[140:143], v[220:223], v[60:63]
v_mfma_f32_16x16x32_bf16 v[56:59], v[136:139], v[208:211], v[56:59]
ds_read_b128 v[132:135], v224 offset:16384
v_mfma_f32_16x16x32_bf16 v[56:59], v[140:143], v[212:215], v[56:59]
v_mfma_f32_16x16x32_bf16 v[52:55], v[136:139], v[200:203], v[52:55]
ds_read_b128 v[176:179], v227 offset:32
v_mfma_f32_16x16x32_bf16 v[52:55], v[140:143], v[204:207], v[52:55]
v_mfma_f32_16x16x32_bf16 v[48:51], v[136:139], v[192:195], v[48:51]
ds_read_b128 v[180:183], v227 offset:8352
v_mfma_f32_16x16x32_bf16 v[48:51], v[140:143], v[196:199], v[48:51]
v_mfma_f32_16x16x32_bf16 v[80:83], v[144:147], v[192:195], v[80:83]
ds_read_b128 v[184:187], v227 offset:48
v_mfma_f32_16x16x32_bf16 v[80:83], v[148:151], v[196:199], v[80:83]
v_mfma_f32_16x16x32_bf16 v[84:87], v[144:147], v[200:203], v[84:87]
ds_read_b128 v[188:191], v227 offset:8368
v_mfma_f32_16x16x32_bf16 v[84:87], v[148:151], v[204:207], v[84:87]
v_mfma_f32_16x16x32_bf16 v[88:91], v[144:147], v[208:211], v[88:91]
ds_read_b128 v[136:139], v224 offset:1024
v_mfma_f32_16x16x32_bf16 v[88:91], v[148:151], v[212:215], v[88:91]
v_mfma_f32_16x16x32_bf16 v[92:95], v[144:147], v[216:219], v[92:95]
ds_read_b128 v[140:143], v224 offset:17408
v_mfma_f32_16x16x32_bf16 v[92:95], v[148:151], v[220:223], v[92:95]
v_mfma_f32_16x16x32_bf16 v[124:127], v[152:155], v[216:219], v[124:127]
ds_read_b128 v[144:147], v224 offset:2048
v_mfma_f32_16x16x32_bf16 v[124:127], v[156:159], v[220:223], v[124:127]
v_mfma_f32_16x16x32_bf16 v[120:123], v[152:155], v[208:211], v[120:123]
ds_read_b128 v[148:151], v224 offset:18432
v_mfma_f32_16x16x32_bf16 v[120:123], v[156:159], v[212:215], v[120:123]
v_mfma_f32_16x16x32_bf16 v[116:119], v[152:155], v[200:203], v[116:119]
v_mfma_f32_16x16x32_bf16 v[116:119], v[156:159], v[204:207], v[116:119]
v_mfma_f32_16x16x32_bf16 v[112:115], v[152:155], v[192:195], v[112:115]
v_mfma_f32_16x16x32_bf16 v[112:115], v[156:159], v[196:199], v[112:115]
s_waitcnt lgkmcnt(4)
v_mfma_f32_16x16x32_bf16 v[0:3], v[128:131], v[160:163], v[0:3]
ds_read_b128 v[152:155], v224 offset:3072
v_mfma_f32_16x16x32_bf16 v[0:3], v[132:135], v[164:167], v[0:3]
v_mfma_f32_16x16x32_bf16 v[4:7], v[128:131], v[168:171], v[4:7]
ds_read_b128 v[156:159], v224 offset:19456
v_mfma_f32_16x16x32_bf16 v[4:7], v[132:135], v[172:175], v[4:7]
v_mfma_f32_16x16x32_bf16 v[8:11], v[128:131], v[176:179], v[8:11]
ds_read_b128 v[192:195], v227 offset:64
v_mfma_f32_16x16x32_bf16 v[8:11], v[132:135], v[180:183], v[8:11]
v_mfma_f32_16x16x32_bf16 v[12:15], v[128:131], v[184:187], v[12:15]
ds_read_b128 v[196:199], v227 offset:8384
v_mfma_f32_16x16x32_bf16 v[12:15], v[132:135], v[188:191], v[12:15]
s_waitcnt lgkmcnt(6)
v_mfma_f32_16x16x32_bf16 v[44:47], v[136:139], v[184:187], v[44:47]
ds_read_b128 v[200:203], v227 offset:80
v_mfma_f32_16x16x32_bf16 v[44:47], v[140:143], v[188:191], v[44:47]
v_mfma_f32_16x16x32_bf16 v[40:43], v[136:139], v[176:179], v[40:43]
ds_read_b128 v[204:207], v227 offset:8400
v_mfma_f32_16x16x32_bf16 v[40:43], v[140:143], v[180:183], v[40:43]
v_mfma_f32_16x16x32_bf16 v[36:39], v[136:139], v[168:171], v[36:39]
ds_read_b128 v[208:211], v227 offset:96
v_mfma_f32_16x16x32_bf16 v[36:39], v[140:143], v[172:175], v[36:39]
v_mfma_f32_16x16x32_bf16 v[32:35], v[136:139], v[160:163], v[32:35]
ds_read_b128 v[212:215], v227 offset:8416
v_mfma_f32_16x16x32_bf16 v[32:35], v[140:143], v[164:167], v[32:35]
s_waitcnt lgkmcnt(8)
v_mfma_f32_16x16x32_bf16 v[64:67], v[144:147], v[160:163], v[64:67]
ds_read_b128 v[216:219], v227 offset:112
v_mfma_f32_16x16x32_bf16 v[64:67], v[148:151], v[164:167], v[64:67]
v_mfma_f32_16x16x32_bf16 v[68:71], v[144:147], v[168:171], v[68:71]
ds_read_b128 v[220:223], v227 offset:8432
v_mfma_f32_16x16x32_bf16 v[68:71], v[148:151], v[172:175], v[68:71]
v_mfma_f32_16x16x32_bf16 v[72:75], v[144:147], v[176:179], v[72:75]
v_mfma_f32_16x16x32_bf16 v[72:75], v[148:151], v[180:183], v[72:75]
s_sub_u32 s23, s23, 1
v_mfma_f32_16x16x32_bf16 v[76:79], v[144:147], v[184:187], v[76:79]
v_mfma_f32_16x16x32_bf16 v[76:79], v[148:151], v[188:191], v[76:79]
s_cmp_lg_u32 s23, 0
s_waitcnt lgkmcnt(8)
v_mfma_f32_16x16x32_bf16 v[108:111], v[152:155], v[184:187], v[108:111]
v_mfma_f32_16x16x32_bf16 v[108:111], v[156:159], v[188:191], v[108:111]
v_mfma_f32_16x16x32_bf16 v[104:107], v[152:155], v[176:179], v[104:107]
v_mfma_f32_16x16x32_bf16 v[104:107], v[156:159], v[180:183], v[104:107]
v_mfma_f32_16x16x32_bf16 v[100:103], v[152:155], v[168:171], v[100:103]
s_waitcnt lgkmcnt(0)
v_mfma_f32_16x16x32_bf16 v[100:103], v[156:159], v[172:175], v[100:103]
s_barrier
v_mfma_f32_16x16x32_bf16 v[96:99], v[152:155], v[160:163], v[96:99]
v_mfma_f32_16x16x32_bf16 v[96:99], v[156:159], v[164:167], v[96:99]
s_cbranch_scc1 Lc_loop
Lc_tail:
v_mfma_f32_16x16x32_bf16 v[16:19], v[128:131], v[192:195], v[16:19]
ds_read_b128 v[160:163], v227 offset:16640
v_mfma_f32_16x16x32_bf16 v[16:19], v[132:135], v[196:199], v[16:19]
v_mfma_f32_16x16x32_bf16 v[20:23], v[128:131], v[200:203], v[20:23]
ds_read_b128 v[164:167], v227 offset:24960
v_mfma_f32_16x16x32_bf16 v[20:23], v[132:135], v[204:207], v[20:23]
v_mfma_f32_16x16x32_bf16 v[24:27], v[128:131], v[208:211], v[24:27]
ds_read_b128 v[168:171], v227 offset:16656
v_mfma_f32_16x16x32_bf16 v[24:27], v[132:135], v[212:215], v[24:27]
v_mfma_f32_16x16x32_bf16 v[28:31], v[128:131], v[216:219], v[28:31]
ds_read_b128 v[172:175], v227 offset:24976
v_mfma_f32_16x16x32_bf16 v[28:31], v[132:135], v[220:223], v[28:31]
v_mfma_f32_16x16x32_bf16 v[60:63], v[136:139], v[216:219], v[60:63]
ds_read_b128 v[176:179], v227 offset:16672
v_mfma_f32_16x16x32_bf16 v[60:63], v[140:143], v[220:223], v[60:63]
v_mfma_f32_16x16x32_bf16 v[56:59], v[136:139], v[208:211], v[56:59]
ds_read_b128 v[180:183], v227 offset:24992
v_mfma_f32_16x16x32_bf16 v[56:59], v[140:143], v[212:215], v[56:59]
v_mfma_f32_16x16x32_bf16 v[52:55], v[136:139], v[200:203], v[52:55]
ds_read_b128 v[184:187], v227 offset:16688
v_mfma_f32_16x16x32_bf16 v[52:55], v[140:143], v[204:207], v[52:55]
v_mfma_f32_16x16x32_bf16 v[48:51], v[136:139], v[192:195], v[48:51]
ds_read_b128 v[188:191], v227 offset:25008
v_mfma_f32_16x16x32_bf16 v[48:51], v[140:143], v[196:199], v[48:51]
v_mfma_f32_16x16x32_bf16 v[80:83], v[144:147], v[192:195], v[80:83]
ds_read_b128 v[128:131], v225 offset:0
v_mfma_f32_16x16x32_bf16 v[80:83], v[148:151], v[196:199], v[80:83]
v_mfma_f32_16x16x32_bf16 v[84:87], v[144:147], v[200:203], v[84:87]
ds_read_b128 v[132:135], v225 offset:16384
v_mfma_f32_16x16x32_bf16 v[84:87], v[148:151], v[204:207], v[84:87]
v_mfma_f32_16x16x32_bf16 v[88:91], v[144:147], v[208:211], v[88:91]
ds_read_b128 v[136:139], v225 offset:1024
v_mfma_f32_16x16x32_bf16 v[88:91], v[148:151], v[212:215], v[88:91]
v_mfma_f32_16x16x32_bf16 v[92:95], v[144:147], v[216:219], v[92:95]
ds_read_b128 v[140:143], v225 offset:17408
v_mfma_f32_16x16x32_bf16 v[92:95], v[148:151], v[220:223], v[92:95]
v_mfma_f32_16x16x32_bf16 v[124:127], v[152:155], v[216:219], v[124:127]
v_mfma_f32_16x16x32_bf16 v[124:127], v[156:159], v[220:223], v[124:127]
v_mfma_f32_16x16x32_bf16 v[120:123], v[152:155], v[208:211], v[120:123]
v_mfma_f32_16x16x32_bf16 v[120:123], v[156:159], v[212:215], v[120:123]
v_mfma_f32_16x16x32_bf16 v[116:119], v[152:155], v[200:203], v[116:119]
v_mfma_f32_16x16x32_bf16 v[116:119], v[156:159], v[204:207], v[116:119]
v_mfma_f32_16x16x32_bf16 v[112:115], v[152:155], v[192:195], v[112:115]
v_mfma_f32_16x16x32_bf16 v[112:115], v[156:159], v[196:199], v[112:115]
s_waitcnt lgkmcnt(2)
v_mfma_f32_16x16x32_bf16 v[0:3], v[128:131], v[160:163], v[0:3]
ds_read_b128 v[192:195], v227 offset:16704
v_mfma_f32_16x16x32_bf16 v[0:3], v[132:135], v[164:167], v[0:3]
ds_read_b128 v[196:199], v227 offset:25024
v_mfma_f32_16x16x32_bf16 v[4:7], v[128:131], v[168:171], v[4:7]
ds_read_b128 v[200:203], v227 offset:16720
v_mfma_f32_16x16x32_bf16 v[4:7], v[132:135], v[172:175], v[4:7]
ds_read_b128 v[204:207], v227 offset:25040
v_mfma_f32_16x16x32_bf16 v[8:11], v[128:131], v[176:179], v[8:11]
ds_read_b128 v[208:211], v227 offset:16736
v_mfma_f32_16x16x32_bf16 v[8:11], v[132:135], v[180:183], v[8:11]
ds_read_b128 v[212:215], v227 offset:25056
v_mfma_f32_16x16x32_bf16 v[12:15], v[128:131], v[184:187], v[12:15]
ds_read_b128 v[216:219], v227 offset:16752
v_mfma_f32_16x16x32_bf16 v[12:15], v[132:135], v[188:191], v[12:15]
ds_read_b128 v[220:223], v227 offset:25072
s_waitcnt lgkmcnt(8)
v_mfma_f32_16x16x32_bf16 v[44:47], v[136:139], v[184:187], v[44:47]
v_mfma_f32_16x16x32_bf16 v[44:47], v[140:143], v[188:191], v[44:47]
v_mfma_f32_16x16x32_bf16 v[40:43], v[136:139], v[176:179], v[40:43]
v_mfma_f32_16x16x32_bf16 v[40:43], v[140:143], v[180:183], v[40:43]
v_mfma_f32_16x16x32_bf16 v[36:39], v[136:139], v[168:171], v[36:39]
v_mfma_f32_16x16x32_bf16 v[36:39], v[140:143], v[172:175], v[36:39]
v_mfma_f32_16x16x32_bf16 v[32:35], v[136:139], v[160:163], v[32:35]
v_mfma_f32_16x16x32_bf16 v[32:35], v[140:143], v[164:167], v[32:35]
s_barrier
s_waitcnt lgkmcnt(4)
v_mfma_f32_16x16x32_bf16 v[16:19], v[128:131], v[192:195], v[16:19]
ds_read_b128 v[144:147], v226 offset:0
v_mfma_f32_16x16x32_bf16 v[16:19], v[132:135], v[196:199], v[16:19]
ds_read_b128 v[148:151], v226 offset:16384
v_mfma_f32_16x16x32_bf16 v[20:23], v[128:131], v[200:203], v[20:23]
ds_read_b128 v[160:163], v227 offset:33280
v_mfma_f32_16x16x32_bf16 v[20:23], v[132:135], v[204:207], v[20:23]
ds_read_b128 v[164:167], v227 offset:41600
s_waitcnt lgkmcnt(4)
v_mfma_f32_16x16x32_bf16 v[24:27], v[128:131], v[208:211], v[24:27]
ds_read_b128 v[168:171], v227 offset:33296
v_mfma_f32_16x16x32_bf16 v[24:27], v[132:135], v[212:215], v[24:27]
ds_read_b128 v[172:175], v227 offset:41616
v_mfma_f32_16x16x32_bf16 v[28:31], v[128:131], v[216:219], v[28:31]
ds_read_b128 v[176:179], v227 offset:33312
v_mfma_f32_16x16x32_bf16 v[28:31], v[132:135], v[220:223], v[28:31]
ds_read_b128 v[180:183], v227 offset:41632
v_mfma_f32_16x16x32_bf16 v[60:63], v[136:139], v[216:219], v[60:63]
ds_read_b128 v[184:187], v227 offset:33328
v_mfma_f32_16x16x32_bf16 v[60:63], v[140:143], v[220:223], v[60:63]
ds_read_b128 v[188:191], v227 offset:41648
v_mfma_f32_16x16x32_bf16 v[56:59], v[136:139], v[208:211], v[56:59]
ds_read_b128 v[152:155], v226 offset:1024
v_mfma_f32_16x16x32_bf16 v[56:59], v[140:143], v[212:215], v[56:59]
ds_read_b128 v[156:159], v226 offset:17408
v_mfma_f32_16x16x32_bf16 v[52:55], v[136:139], v[200:203], v[52:55]
v_mfma_f32_16x16x32_bf16 v[52:55], v[140:143], v[204:207], v[52:55]
v_mfma_f32_16x16x32_bf16 v[48:51], v[136:139], v[192:195], v[48:51]
v_mfma_f32_16x16x32_bf16 v[48:51], v[140:143], v[196:199], v[48:51]
s_waitcnt lgkmcnt(6)
v_mfma_f32_16x16x32_bf16 v[0:3], v[144:147], v[160:163], v[0:3]
ds_read_b128 v[192:195], v227 offset:33344
v_mfma_f32_16x16x32_bf16 v[0:3], v[148:151], v[164:167], v[0:3]
ds_read_b128 v[196:199], v227 offset:41664
v_mfma_f32_16x16x32_bf16 v[4:7], v[144:147], v[168:171], v[4:7]
ds_read_b128 v[200:203], v227 offset:33360
v_mfma_f32_16x16x32_bf16 v[4:7], v[148:151], v[172:175], v[4:7]
ds_read_b128 v[204:207], v227 offset:41680
s_waitcnt lgkmcnt(6)
v_mfma_f32_16x16x32_bf16 v[8:11], v[144:147], v[176:179], v[8:11]
ds_read_b128 v[208:211], v227 offset:33376
v_mfma_f32_16x16x32_bf16 v[8:11], v[148:151], v[180:183], v[8:11]
ds_read_b128 v[212:215], v227 offset:41696
v_mfma_f32_16x16x32_bf16 v[12:15], v[144:147], v[184:187], v[12:15]
ds_read_b128 v[216:219], v227 offset:33392
v_mfma_f32_16x16x32_bf16 v[12:15], v[148:151], v[188:191], v[12:15]
ds_read_b128 v[220:223], v227 offset:41712
s_waitcnt lgkmcnt(8)
v_mfma_f32_16x16x32_bf16 v[44:47], v[152:155], v[184:187], v[44:47]
v_mfma_f32_16x16x32_bf16 v[44:47], v[156:159], v[188:191], v[44:47]
v_mfma_f32_16x16x32_bf16 v[40:43], v[152:155], v[176:179], v[40:43]
v_mfma_f32_16x16x32_bf16 v[40:43], v[156:159], v[180:183], v[40:43]
v_mfma_f32_16x16x32_bf16 v[36:39], v[152:155], v[168:171], v[36:39]
v_mfma_f32_16x16x32_bf16 v[36:39], v[156:159], v[172:175], v[36:39]
v_mfma_f32_16x16x32_bf16 v[32:35], v[152:155], v[160:163], v[32:35]
v_mfma_f32_16x16x32_bf16 v[32:35], v[156:159], v[164:167], v[32:35]
s_barrier
s_waitcnt lgkmcnt(4)
v_mfma_f32_16x16x32_bf16 v[16:19], v[144:147], v[192:195], v[16:19]
ds_read_b128 v[128:131], v224 offset:0
v_mfma_f32_16x16x32_bf16 v[16:19], v[148:151], v[196:199], v[16:19]
ds_read_b128 v[132:135], v224 offset:16384
v_mfma_f32_16x16x32_bf16 v[20:23], v[144:147], v[200:203], v[20:23]
ds_read_b128 v[160:163], v227 offset:0
v_mfma_f32_16x16x32_bf16 v[20:23], v[148:151], v[204:207], v[20:23]
ds_read_b128 v[164:167], v227 offset:8320
s_waitcnt lgkmcnt(4)
v_mfma_f32_16x16x32_bf16 v[24:27], v[144:147], v[208:211], v[24:27]
ds_read_b128 v[168:171], v227 offset:16
v_mfma_f32_16x16x32_bf16 v[24:27], v[148:151], v[212:215], v[24:27]
ds_read_b128 v[172:175], v227 offset:8336
v_mfma_f32_16x16x32_bf16 v[28:31], v[144:147], v[216:219], v[28:31]
ds_read_b128 v[176:179], v227 offset:32
v_mfma_f32_16x16x32_bf16 v[28:31], v[148:151], v[220:223], v[28:31]
ds_read_b128 v[180:183], v227 offset:8352
v_mfma_f32_16x16x32_bf16 v[60:63], v[152:155], v[216:219], v[60:63]
ds_read_b128 v[184:187], v227 offset:48
v_mfma_f32_16x16x32_bf16 v[60:63], v[156:159], v[220:223], v[60:63]
ds_read_b128 v[188:191], v227 offset:8368
v_mfma_f32_16x16x32_bf16 v[56:59], v[152:155], v[208:211], v[56:59]
ds_read_b128 v[136:139], v224 offset:1024
v_mfma_f32_16x16x32_bf16 v[56:59], v[156:159], v[212:215], v[56:59]
ds_read_b128 v[140:143], v224 offset:17408
v_mfma_f32_16x16x32_bf16 v[52:55], v[152:155], v[200:203], v[52:55]
v_mfma_f32_16x16x32_bf16 v[52:55], v[156:159], v[204:207], v[52:55]
v_mfma_f32_16x16x32_bf16 v[48:51], v[152:155], v[192:195], v[48:51]
v_mfma_f32_16x16x32_bf16 v[48:51], v[156:159], v[196:199], v[48:51]
s_waitcnt lgkmcnt(6)
v_mfma_f32_16x16x32_bf16 v[0:3], v[128:131], v[160:163], v[0:3]
ds_read_b128 v[192:195], v227 offset:64
v_mfma_f32_16x16x32_bf16 v[0:3], v[132:135], v[164:167], v[0:3]
ds_read_b128 v[196:199], v227 offset:8384
v_mfma_f32_16x16x32_bf16 v[4:7], v[128:131], v[168:171], v[4:7]
ds_read_b128 v[200:203], v227 offset:80
v_mfma_f32_16x16x32_bf16 v[4:7], v[132:135], v[172:175], v[4:7]
ds_read_b128 v[204:207], v227 offset:8400
s_waitcnt lgkmcnt(6)
v_mfma_f32_16x16x32_bf16 v[8:11], v[128:131], v[176:179], v[8:11]
ds_read_b128 v[208:211], v227 offset:96
v_mfma_f32_16x16x32_bf16 v[8:11], v[132:135], v[180:183], v[8:11]
ds_read_b128 v[212:215], v227 offset:8416
v_mfma_f32_16x16x32_bf16 v[12:15], v[128:131], v[184:187], v[12:15]
ds_read_b128 v[216:219], v227 offset:112
v_mfma_f32_16x16x32_bf16 v[12:15], v[132:135], v[188:191], v[12:15]
ds_read_b128 v[220:223], v227 offset:8432
s_waitcnt lgkmcnt(8)
v_mfma_f32_16x16x32_bf16 v[44:47], v[136:139], v[184:187], v[44:47]
v_mfma_f32_16x16x32_bf16 v[44:47], v[140:143], v[188:191], v[44:47]
v_mfma_f32_16x16x32_bf16 v[40:43], v[136:139], v[176:179], v[40:43]
v_mfma_f32_16x16x32_bf16 v[40:43], v[140:143], v[180:183], v[40:43]
v_mfma_f32_16x16x32_bf16 v[36:39], v[136:139], v[168:171], v[36:39]
v_mfma_f32_16x16x32_bf16 v[36:39], v[140:143], v[172:175], v[36:39]
v_mfma_f32_16x16x32_bf16 v[32:35], v[136:139], v[160:163], v[32:35]
v_mfma_f32_16x16x32_bf16 v[32:35], v[140:143], v[164:167], v[32:35]
s_waitcnt lgkmcnt(4)
v_mfma_f32_16x16x32_bf16 v[16:19], v[128:131], v[192:195], v[16:19]
ds_read_b128 v[144:147], v225 offset:2048
v_mfma_f32_16x16x32_bf16 v[16:19], v[132:135], v[196:199], v[16:19]
ds_read_b128 v[148:151], v225 offset:18432
v_mfma_f32_16x16x32_bf16 v[20:23], v[128:131], v[200:203], v[20:23]
ds_read_b128 v[160:163], v227 offset:16640
v_mfma_f32_16x16x32_bf16 v[20:23], v[132:135], v[204:207], v[20:23]
ds_read_b128 v[164:167], v227 offset:24960
s_waitcnt lgkmcnt(4)
v_mfma_f32_16x16x32_bf16 v[24:27], v[128:131], v[208:211], v[24:27]
ds_read_b128 v[168:171], v227 offset:16656
v_mfma_f32_16x16x32_bf16 v[24:27], v[132:135], v[212:215], v[24:27]
ds_read_b128 v[172:175], v227 offset:24976
v_mfma_f32_16x16x32_bf16 v[28:31], v[128:131], v[216:219], v[28:31]
ds_read_b128 v[176:179], v227 offset:16672
v_mfma_f32_16x16x32_bf16 v[28:31], v[132:135], v[220:223], v[28:31]
ds_read_b128 v[180:183], v227 offset:24992
v_mfma_f32_16x16x32_bf16 v[60:63], v[136:139], v[216:219], v[60:63]
ds_read_b128 v[184:187], v227 offset:16688
v_mfma_f32_16x16x32_bf16 v[60:63], v[140:143], v[220:223], v[60:63]
ds_read_b128 v[188:191], v227 offset:25008
v_mfma_f32_16x16x32_bf16 v[56:59], v[136:139], v[208:211], v[56:59]
ds_read_b128 v[152:155], v225 offset:3072
v_mfma_f32_16x16x32_bf16 v[56:59], v[140:143], v[212:215], v[56:59]
ds_read_b128 v[156:159], v225 offset:19456
v_mfma_f32_16x16x32_bf16 v[52:55], v[136:139], v[200:203], v[52:55]
v_mfma_f32_16x16x32_bf16 v[52:55], v[140:143], v[204:207], v[52:55]
v_mfma_f32_16x16x32_bf16 v[48:51], v[136:139], v[192:195], v[48:51]
v_mfma_f32_16x16x32_bf16 v[48:51], v[140:143], v[196:199], v[48:51]
s_waitcnt lgkmcnt(6)
v_mfma_f32_16x16x32_bf16 v[64:67], v[144:147], v[160:163], v[64:67]
ds_read_b128 v[192:195], v227 offset:16704
v_mfma_f32_16x16x32_bf16 v[64:67], v[148:151], v[164:167], v[64:67]
ds_read_b128 v[196:199], v227 offset:25024
v_mfma_f32_16x16x32_bf16 v[68:71], v[144:147], v[168:171], v[68:71]
ds_read_b128 v[200:203], v227 offset:16720
v_cvt_pk_bf16_f32 v240, v0, v4
v_cvt_pk_bf16_f32 v241, v8, v12
v_mfma_f32_16x16x32_bf16 v[68:71], v[148:151], v[172:175], v[68:71]
ds_read_b128 v[204:207], v227 offset:25040
v_cvt_pk_bf16_f32 v242, v16, v20
v_cvt_pk_bf16_f32 v243, v24, v28
s_waitcnt lgkmcnt(6)
v_mfma_f32_16x16x32_bf16 v[72:75], v[144:147], v[176:179], v[72:75]
ds_read_b128 v[208:211], v227 offset:16736
buffer_store_dwordx4 v[240:243], v229, s[16:19], s24 offen sc1
s_add_u32 s24, s24, 7168
v_mfma_f32_16x16x32_bf16 v[72:75], v[148:151], v[180:183], v[72:75]
ds_read_b128 v[212:215], v227 offset:25056
v_mfma_f32_16x16x32_bf16 v[76:79], v[144:147], v[184:187], v[76:79]
ds_read_b128 v[216:219], v227 offset:16752
v_mfma_f32_16x16x32_bf16 v[76:79], v[148:151], v[188:191], v[76:79]
ds_read_b128 v[220:223], v227 offset:25072
s_waitcnt lgkmcnt(8)
v_mfma_f32_16x16x32_bf16 v[108:111], v[152:155], v[184:187], v[108:111]
v_cvt_pk_bf16_f32 v244, v1, v5
v_cvt_pk_bf16_f32 v245, v9, v13
v_mfma_f32_16x16x32_bf16 v[108:111], v[156:159], v[188:191], v[108:111]
v_cvt_pk_bf16_f32 v246, v17, v21
v_cvt_pk_bf16_f32 v247, v25, v29
v_mfma_f32_16x16x32_bf16 v[104:107], v[152:155], v[176:179], v[104:107]
buffer_store_dwordx4 v[244:247], v229, s[16:19], s24 offen sc1
s_add_u32 s24, s24, 7168
v_mfma_f32_16x16x32_bf16 v[104:107], v[156:159], v[180:183], v[104:107]
v_mfma_f32_16x16x32_bf16 v[100:103], v[152:155], v[168:171], v[100:103]
v_cvt_pk_bf16_f32 v240, v2, v6
v_cvt_pk_bf16_f32 v241, v10, v14
v_mfma_f32_16x16x32_bf16 v[100:103], v[156:159], v[172:175], v[100:103]
v_cvt_pk_bf16_f32 v242, v18, v22
v_cvt_pk_bf16_f32 v243, v26, v30
v_mfma_f32_16x16x32_bf16 v[96:99], v[152:155], v[160:163], v[96:99]
buffer_store_dwordx4 v[240:243], v229, s[16:19], s24 offen sc1
s_add_u32 s24, s24, 7168
v_mfma_f32_16x16x32_bf16 v[96:99], v[156:159], v[164:167], v[96:99]
s_waitcnt lgkmcnt(4)
v_mfma_f32_16x16x32_bf16 v[80:83], v[144:147], v[192:195], v[80:83]
ds_read_b128 v[128:131], v226 offset:2048
v_mfma_f32_16x16x32_bf16 v[80:83], v[148:151], v[196:199], v[80:83]
ds_read_b128 v[132:135], v226 offset:18432
v_mfma_f32_16x16x32_bf16 v[84:87], v[144:147], v[200:203], v[84:87]
ds_read_b128 v[160:163], v227 offset:33280
v_mfma_f32_16x16x32_bf16 v[84:87], v[148:151], v[204:207], v[84:87]
ds_read_b128 v[164:167], v227 offset:41600
v_cvt_pk_bf16_f32 v244, v3, v7
v_cvt_pk_bf16_f32 v245, v11, v15
s_waitcnt lgkmcnt(4)
v_mfma_f32_16x16x32_bf16 v[88:91], v[144:147], v[208:211], v[88:91]
ds_read_b128 v[168:171], v227 offset:33296
v_cvt_pk_bf16_f32 v246, v19, v23
v_cvt_pk_bf16_f32 v247, v27, v31
v_mfma_f32_16x16x32_bf16 v[88:91], v[148:151], v[212:215], v[88:91]
ds_read_b128 v[172:175], v227 offset:41616
buffer_store_dwordx4 v[244:247], v229, s[16:19], s24 offen sc1
s_add_u32 s24, s24, 93184
v_mfma_f32_16x16x32_bf16 v[92:95], v[144:147], v[216:219], v[92:95]
ds_read_b128 v[176:179], v227 offset:33312
v_mfma_f32_16x16x32_bf16 v[92:95], v[148:151], v[220:223], v[92:95]
ds_read_b128 v[180:183], v227 offset:41632
v_mfma_f32_16x16x32_bf16 v[124:127], v[152:155], v[216:219], v[124:127]
ds_read_b128 v[184:187], v227 offset:33328
v_cvt_pk_bf16_f32 v240, v32, v36
v_cvt_pk_bf16_f32 v241, v40, v44
v_mfma_f32_16x16x32_bf16 v[124:127], v[156:159], v[220:223], v[124:127]
ds_read_b128 v[188:191], v227 offset:41648
v_cvt_pk_bf16_f32 v242, v48, v52
v_cvt_pk_bf16_f32 v243, v56, v60
v_mfma_f32_16x16x32_bf16 v[120:123], v[152:155], v[208:211], v[120:123]
ds_read_b128 v[136:139], v226 offset:3072
buffer_store_dwordx4 v[240:243], v229, s[16:19], s24 offen sc1
s_add_u32 s24, s24, 7168
v_mfma_f32_16x16x32_bf16 v[120:123], v[156:159], v[212:215], v[120:123]
ds_read_b128 v[140:143], v226 offset:19456
v_mfma_f32_16x16x32_bf16 v[116:119], v[152:155], v[200:203], v[116:119]
v_cvt_pk_bf16_f32 v244, v33, v37
v_cvt_pk_bf16_f32 v245, v41, v45
v_mfma_f32_16x16x32_bf16 v[116:119], v[156:159], v[204:207], v[116:119]
v_cvt_pk_bf16_f32 v246, v49, v53
v_cvt_pk_bf16_f32 v247, v57, v61
v_mfma_f32_16x16x32_bf16 v[112:115], v[152:155], v[192:195], v[112:115]
buffer_store_dwordx4 v[244:247], v229, s[16:19], s24 offen sc1
s_add_u32 s24, s24, 7168
v_mfma_f32_16x16x32_bf16 v[112:115], v[156:159], v[196:199], v[112:115]
s_waitcnt lgkmcnt(6)
v_mfma_f32_16x16x32_bf16 v[64:67], v[128:131], v[160:163], v[64:67]
ds_read_b128 v[192:195], v227 offset:33344
v_mfma_f32_16x16x32_bf16 v[64:67], v[132:135], v[164:167], v[64:67]
ds_read_b128 v[196:199], v227 offset:41664
v_mfma_f32_16x16x32_bf16 v[68:71], v[128:131], v[168:171], v[68:71]
ds_read_b128 v[200:203], v227 offset:33360
v_cvt_pk_bf16_f32 v240, v34, v38
v_cvt_pk_bf16_f32 v241, v42, v46
v_mfma_f32_16x16x32_bf16 v[68:71], v[132:135], v[172:175], v[68:71]
ds_read_b128 v[204:207], v227 offset:41680
v_cvt_pk_bf16_f32 v242, v50, v54
v_cvt_pk_bf16_f32 v243, v58, v62
s_waitcnt lgkmcnt(6)
v_mfma_f32_16x16x32_bf16 v[72:75], v[128:131], v[176:179], v[72:75]
ds_read_b128 v[208:211], v227 offset:33376
buffer_store_dwordx4 v[240:243], v229, s[16:19], s24 offen sc1
s_add_u32 s24, s24, 7168
v_mfma_f32_16x16x32_bf16 v[72:75], v[132:135], v[180:183], v[72:75]
ds_read_b128 v[212:215], v227 offset:41696
v_mfma_f32_16x16x32_bf16 v[76:79], v[128:131], v[184:187], v[76:79]
ds_read_b128 v[216:219], v227 offset:33392
v_mfma_f32_16x16x32_bf16 v[76:79], v[132:135], v[188:191], v[76:79]
ds_read_b128 v[220:223], v227 offset:41712
s_waitcnt lgkmcnt(8)
v_mfma_f32_16x16x32_bf16 v[108:111], v[136:139], v[184:187], v[108:111]
v_cvt_pk_bf16_f32 v244, v35, v39
v_cvt_pk_bf16_f32 v245, v43, v47
v_mfma_f32_16x16x32_bf16 v[108:111], v[140:143], v[188:191], v[108:111]
v_cvt_pk_bf16_f32 v246, v51, v55
v_cvt_pk_bf16_f32 v247, v59, v63
v_mfma_f32_16x16x32_bf16 v[104:107], v[136:139], v[176:179], v[104:107]
buffer_store_dwordx4 v[244:247], v229, s[16:19], s24 offen sc1
s_add_u32 s24, s24, 93184
v_mfma_f32_16x16x32_bf16 v[104:107], v[140:143], v[180:183], v[104:107]
v_mfma_f32_16x16x32_bf16 v[100:103], v[136:139], v[168:171], v[100:103]
v_mfma_f32_16x16x32_bf16 v[100:103], v[140:143], v[172:175], v[100:103]
v_mfma_f32_16x16x32_bf16 v[96:99], v[136:139], v[160:163], v[96:99]
v_mfma_f32_16x16x32_bf16 v[96:99], v[140:143], v[164:167], v[96:99]
s_waitcnt lgkmcnt(4)
v_mfma_f32_16x16x32_bf16 v[80:83], v[128:131], v[192:195], v[80:83]
ds_read_b128 v[144:147], v224 offset:2048
v_mfma_f32_16x16x32_bf16 v[80:83], v[132:135], v[196:199], v[80:83]
ds_read_b128 v[148:151], v224 offset:18432
v_mfma_f32_16x16x32_bf16 v[84:87], v[128:131], v[200:203], v[84:87]
ds_read_b128 v[160:163], v227 offset:0
v_mfma_f32_16x16x32_bf16 v[84:87], v[132:135], v[204:207], v[84:87]
ds_read_b128 v[164:167], v227 offset:8320
s_waitcnt lgkmcnt(4)
v_mfma_f32_16x16x32_bf16 v[88:91], v[128:131], v[208:211], v[88:91]
ds_read_b128 v[168:171], v227 offset:16
v_mfma_f32_16x16x32_bf16 v[88:91], v[132:135], v[212:215], v[88:91]
ds_read_b128 v[172:175], v227 offset:8336
v_mfma_f32_16x16x32_bf16 v[92:95], v[128:131], v[216:219], v[92:95]
ds_read_b128 v[176:179], v227 offset:32
v_mfma_f32_16x16x32_bf16 v[92:95], v[132:135], v[220:223], v[92:95]
ds_read_b128 v[180:183], v227 offset:8352
v_mfma_f32_16x16x32_bf16 v[124:127], v[136:139], v[216:219], v[124:127]
ds_read_b128 v[184:187], v227 offset:48
v_mfma_f32_16x16x32_bf16 v[124:127], v[140:143], v[220:223], v[124:127]
ds_read_b128 v[188:191], v227 offset:8368
v_mfma_f32_16x16x32_bf16 v[120:123], v[136:139], v[208:211], v[120:123]
ds_read_b128 v[152:155], v224 offset:3072
v_mfma_f32_16x16x32_bf16 v[120:123], v[140:143], v[212:215], v[120:123]
ds_read_b128 v[156:159], v224 offset:19456
v_mfma_f32_16x16x32_bf16 v[116:119], v[136:139], v[200:203], v[116:119]
v_mfma_f32_16x16x32_bf16 v[116:119], v[140:143], v[204:207], v[116:119]
v_mfma_f32_16x16x32_bf16 v[112:115], v[136:139], v[192:195], v[112:115]
v_mfma_f32_16x16x32_bf16 v[112:115], v[140:143], v[196:199], v[112:115]
s_waitcnt lgkmcnt(8)
v_mfma_f32_16x16x32_bf16 v[64:67], v[144:147], v[160:163], v[64:67]
ds_read_b128 v[192:195], v227 offset:64
v_mfma_f32_16x16x32_bf16 v[64:67], v[148:151], v[164:167], v[64:67]
ds_read_b128 v[196:199], v227 offset:8384
s_waitcnt lgkmcnt(8)
v_mfma_f32_16x16x32_bf16 v[68:71], v[144:147], v[168:171], v[68:71]
ds_read_b128 v[200:203], v227 offset:80
v_mfma_f32_16x16x32_bf16 v[68:71], v[148:151], v[172:175], v[68:71]
ds_read_b128 v[204:207], v227 offset:8400
s_waitcnt lgkmcnt(8)
v_mfma_f32_16x16x32_bf16 v[72:75], v[144:147], v[176:179], v[72:75]
ds_read_b128 v[208:211], v227 offset:96
v_mfma_f32_16x16x32_bf16 v[72:75], v[148:151], v[180:183], v[72:75]
ds_read_b128 v[212:215], v227 offset:8416
s_waitcnt lgkmcnt(8)
v_mfma_f32_16x16x32_bf16 v[76:79], v[144:147], v[184:187], v[76:79]
ds_read_b128 v[216:219], v227 offset:112
v_mfma_f32_16x16x32_bf16 v[76:79], v[148:151], v[188:191], v[76:79]
ds_read_b128 v[220:223], v227 offset:8432
s_waitcnt lgkmcnt(6)
v_mfma_f32_16x16x32_bf16 v[80:83], v[144:147], v[192:195], v[80:83]
v_mfma_f32_16x16x32_bf16 v[80:83], v[148:151], v[196:199], v[80:83]
s_waitcnt lgkmcnt(4)
v_mfma_f32_16x16x32_bf16 v[84:87], v[144:147], v[200:203], v[84:87]
v_mfma_f32_16x16x32_bf16 v[84:87], v[148:151], v[204:207], v[84:87]
s_waitcnt lgkmcnt(2)
v_mfma_f32_16x16x32_bf16 v[88:91], v[144:147], v[208:211], v[88:91]
v_mfma_f32_16x16x32_bf16 v[88:91], v[148:151], v[212:215], v[88:91]
s_waitcnt lgkmcnt(0)
v_mfma_f32_16x16x32_bf16 v[92:95], v[144:147], v[216:219], v[92:95]
v_mfma_f32_16x16x32_bf16 v[92:95], v[148:151], v[220:223], v[92:95]
v_mfma_f32_16x16x32_bf16 v[124:127], v[152:155], v[216:219], v[124:127]
v_mfma_f32_16x16x32_bf16 v[124:127], v[156:159], v[220:223], v[124:127]
v_mfma_f32_16x16x32_bf16 v[120:123], v[152:155], v[208:211], v[120:123]
v_mfma_f32_16x16x32_bf16 v[120:123], v[156:159], v[212:215], v[120:123]
v_mfma_f32_16x16x32_bf16 v[116:119], v[152:155], v[200:203], v[116:119]
v_mfma_f32_16x16x32_bf16 v[116:119], v[156:159], v[204:207], v[116:119]
v_mfma_f32_16x16x32_bf16 v[112:115], v[152:155], v[192:195], v[112:115]
v_mfma_f32_16x16x32_bf16 v[112:115], v[156:159], v[196:199], v[112:115]
v_cvt_pk_bf16_f32 v240, v64, v68
v_cvt_pk_bf16_f32 v241, v72, v76
v_mfma_f32_16x16x32_bf16 v[108:111], v[152:155], v[184:187], v[108:111]
v_cvt_pk_bf16_f32 v242, v80, v84
v_cvt_pk_bf16_f32 v243, v88, v92
v_mfma_f32_16x16x32_bf16 v[108:111], v[156:159], v[188:191], v[108:111]
buffer_store_dwordx4 v[240:243], v229, s[16:19], s24 offen sc1
s_add_u32 s24, s24, 7168
v_mfma_f32_16x16x32_bf16 v[104:107], v[152:155], v[176:179], v[104:107]
v_cvt_pk_bf16_f32 v244, v65, v69
v_cvt_pk_bf16_f32 v245, v73, v77
v_mfma_f32_16x16x32_bf16 v[104:107], v[156:159], v[180:183], v[104:107]
v_cvt_pk_bf16_f32 v246, v81, v85
v_cvt_pk_bf16_f32 v247, v89, v93
v_mfma_f32_16x16x32_bf16 v[100:103], v[152:155], v[168:171], v[100:103]
buffer_store_dwordx4 v[244:247], v229, s[16:19], s24 offen sc1
s_add_u32 s24, s24, 7168
v_mfma_f32_16x16x32_bf16 v[100:103], v[156:159], v[172:175], v[100:103]
v_cvt_pk_bf16_f32 v240, v66, v70
v_cvt_pk_bf16_f32 v241, v74, v78
v_mfma_f32_16x16x32_bf16 v[96:99], v[152:155], v[160:163], v[96:99]
v_cvt_pk_bf16_f32 v242, v82, v86
v_cvt_pk_bf16_f32 v243, v90, v94
v_mfma_f32_16x16x32_bf16 v[96:99], v[156:159], v[164:167], v[96:99]
buffer_store_dwordx4 v[240:243], v229, s[16:19], s24 offen sc1
s_add_u32 s24, s24, 7168
v_cvt_pk_bf16_f32 v244, v67, v71
v_cvt_pk_bf16_f32 v245, v75, v79
v_cvt_pk_bf16_f32 v246, v83, v87
v_cvt_pk_bf16_f32 v247, v91, v95
buffer_store_dwordx4 v[244:247], v229, s[16:19], s24 offen sc1
s_add_u32 s24, s24, 93184
s_nop 1
v_cvt_pk_bf16_f32 v128, v96, v100
v_cvt_pk_bf16_f32 v129, v104, v108
v_cvt_pk_bf16_f32 v130, v112, v116
v_cvt_pk_bf16_f32 v131, v120, v124
buffer_store_dwordx4 v[128:131], v229, s[16:19], s24 offen sc1
s_add_u32 s24, s24, 7168
v_cvt_pk_bf16_f32 v132, v97, v101
v_cvt_pk_bf16_f32 v133, v105, v109
v_cvt_pk_bf16_f32 v134, v113, v117
v_cvt_pk_bf16_f32 v135, v121, v125
buffer_store_dwordx4 v[132:135], v229, s[16:19], s24 offen sc1
s_add_u32 s24, s24, 7168
v_cvt_pk_bf16_f32 v136, v98, v102
v_cvt_pk_bf16_f32 v137, v106, v110
v_cvt_pk_bf16_f32 v138, v114, v118
v_cvt_pk_bf16_f32 v139, v122, v126
buffer_store_dwordx4 v[136:139], v229, s[16:19], s24 offen sc1
s_add_u32 s24, s24, 7168
v_cvt_pk_bf16_f32 v140, v99, v103
v_cvt_pk_bf16_f32 v141, v107, v111
v_cvt_pk_bf16_f32 v142, v115, v119
v_cvt_pk_bf16_f32 v143, v123, v127
buffer_store_dwordx4 v[140:143], v229, s[16:19], s24 offen sc1
s_add_u32 s24, s24, 93184
s_or_b32 s14, s2, s3
s_cmp_lg_u32 s14, 0
s_cbranch_scc1 Lc_end
s_mov_b32 s14, 258048
v_mov_b32 v240, s52
v_mov_b32 v241, s52
v_mov_b32 v242, s52
v_mov_b32 v243, s52
s_mov_b64 exec, 0xff
buffer_store_dwordx4 v[240:243], v248, s[56:59], s14 offen sc1
s_mov_b64 exec, -1
Lc_end:
s_endpgm
Lc_peel:
v_mfma_f32_16x16x32_bf16 v[96:99], v[152:155], v[160:163], v[96:99]
v_mfma_f32_16x16x32_bf16 v[96:99], v[156:159], v[164:167], v[96:99]
v_mfma_f32_16x16x32_bf16 v[16:19], v[128:131], v[192:195], v[16:19]
v_mfma_f32_16x16x32_bf16 v[16:19], v[132:135], v[196:199], v[16:19]
v_mfma_f32_16x16x32_bf16 v[20:23], v[128:131], v[200:203], v[20:23]
v_mfma_f32_16x16x32_bf16 v[20:23], v[132:135], v[204:207], v[20:23]
v_mfma_f32_16x16x32_bf16 v[24:27], v[128:131], v[208:211], v[24:27]
v_mfma_f32_16x16x32_bf16 v[24:27], v[132:135], v[212:215], v[24:27]
v_mfma_f32_16x16x32_bf16 v[28:31], v[128:131], v[216:219], v[28:31]
v_mfma_f32_16x16x32_bf16 v[28:31], v[132:135], v[220:223], v[28:31]
v_mfma_f32_16x16x32_bf16 v[60:63], v[136:139], v[216:219], v[60:63]
v_mfma_f32_16x16x32_bf16 v[60:63], v[140:143], v[220:223], v[60:63]
v_mfma_f32_16x16x32_bf16 v[56:59], v[136:139], v[208:211], v[56:59]
v_mfma_f32_16x16x32_bf16 v[56:59], v[140:143], v[212:215], v[56:59]
v_mfma_f32_16x16x32_bf16 v[52:55], v[136:139], v[200:203], v[52:55]
v_mfma_f32_16x16x32_bf16 v[52:55], v[140:143], v[204:207], v[52:55]
v_mfma_f32_16x16x32_bf16 v[48:51], v[136:139], v[192:195], v[48:51]
v_mfma_f32_16x16x32_bf16 v[48:51], v[140:143], v[196:199], v[48:51]
v_mfma_f32_16x16x32_bf16 v[80:83], v[144:147], v[192:195], v[80:83]
v_mfma_f32_16x16x32_bf16 v[80:83], v[148:151], v[196:199], v[80:83]
v_mfma_f32_16x16x32_bf16 v[84:87], v[144:147], v[200:203], v[84:87]
v_mfma_f32_16x16x32_bf16 v[84:87], v[148:151], v[204:207], v[84:87]
v_mfma_f32_16x16x32_bf16 v[88:91], v[144:147], v[208:211], v[88:91]
v_mfma_f32_16x16x32_bf16 v[88:91], v[148:151], v[212:215], v[88:91]
v_mfma_f32_16x16x32_bf16 v[92:95], v[144:147], v[216:219], v[92:95]
v_mfma_f32_16x16x32_bf16 v[92:95], v[148:151], v[220:223], v[92:95]
v_mfma_f32_16x16x32_bf16 v[124:127], v[152:155], v[216:219], v[124:127]
v_mfma_f32_16x16x32_bf16 v[124:127], v[156:159], v[220:223], v[124:127]
v_mfma_f32_16x16x32_bf16 v[120:123], v[152:155], v[208:211], v[120:123]
v_mfma_f32_16x16x32_bf16 v[120:123], v[156:159], v[212:215], v[120:123]
v_mfma_f32_16x16x32_bf16 v[116:119], v[152:155], v[200:203], v[116:119]
v_mfma_f32_16x16x32_bf16 v[116:119], v[156:159], v[204:207], v[116:119]
v_mfma_f32_16x16x32_bf16 v[112:115], v[152:155], v[192:195], v[112:115]
v_mfma_f32_16x16x32_bf16 v[112:115], v[156:159], v[196:199], v[112:115]
s_barrier
ds_read_b128 v[128:131], v226 offset:0
ds_read_b128 v[132:135], v226 offset:16384
ds_read_b128 v[160:163], v227 offset:33280
ds_read_b128 v[164:167], v227 offset:41600
ds_read_b128 v[168:171], v227 offset:33296
ds_read_b128 v[172:175], v227 offset:41616
ds_read_b128 v[176:179], v227 offset:33312
ds_read_b128 v[180:183], v227 offset:41632
ds_read_b128 v[184:187], v227 offset:33328
ds_read_b128 v[188:191], v227 offset:41648
ds_read_b128 v[136:139], v226 offset:1024
ds_read_b128 v[140:143], v226 offset:17408
ds_read_b128 v[144:147], v226 offset:2048
ds_read_b128 v[148:151], v226 offset:18432
s_branch Lc_mid
Lc_h:
v_mfma_f32_16x16x32_bf16 v[136:139], v[208:211], v[192:195], v[136:139]
v_mfma_f32_16x16x32_bf16 v[140:143], v[212:215], v[192:195], v[140:143]
v_mfma_f32_16x16x32_bf16 v[148:151], v[212:215], v[196:199], v[148:151]
v_mfma_f32_16x16x32_bf16 v[144:147], v[208:211], v[196:199], v[144:147]
v_mfma_f32_16x16x32_bf16 v[152:155], v[208:211], v[200:203], v[152:155]
v_mfma_f32_16x16x32_bf16 v[156:159], v[212:215], v[200:203], v[156:159]
v_mfma_f32_16x16x32_bf16 v[164:167], v[212:215], v[204:207], v[164:167]
v_mfma_f32_16x16x32_bf16 v[160:163], v[208:211], v[204:207], v[160:163]
s_nop 7
v_cvt_pk_bf16_f32 v240, v136, v137
v_cvt_pk_bf16_f32 v241, v138, v139
v_cvt_pk_bf16_f32 v242, v140, v141
v_cvt_pk_bf16_f32 v243, v142, v143
buffer_store_dwordx4 v[240:243], v248, s[16:19], s24 offen offset:0 sc1
v_cvt_pk_bf16_f32 v244, v144, v145
v_cvt_pk_bf16_f32 v245, v146, v147
v_cvt_pk_bf16_f32 v246, v148, v149
v_cvt_pk_bf16_f32 v247, v150, v151
buffer_store_dwordx4 v[244:247], v248, s[16:19], s24 offen offset:1024 sc1
v_cvt_pk_bf16_f32 v240, v152, v153
v_cvt_pk_bf16_f32 v241, v154, v155
v_cvt_pk_bf16_f32 v242, v156, v157
v_cvt_pk_bf16_f32 v243, v158, v159
buffer_store_dwordx4 v[240:243], v248, s[16:19], s24 offen offset:2048 sc1
v_cvt_pk_bf16_f32 v244, v160, v161
v_cvt_pk_bf16_f32 v245, v162, v163
v_cvt_pk_bf16_f32 v246, v164, v165
v_cvt_pk_bf16_f32 v247, v166, v167
buffer_store_dwordx4 v[244:247], v248, s[16:19], s24 offen offset:3072 sc1
s_waitcnt vmcnt(0)
s_barrier
s_cmp_lg_u32 s3, 0
s_cbranch_scc1 Lc_end
s_lshl_b32 s27, s6, 3
s_add_u32 s27, s27, s7
s_lshl_b32 s27, s27, 8
s_add_u32 s27, s27, 131072
v_mov_b32 v240, s52
v_mov_b32 v241, s52
v_mov_b32 v242, s52
v_mov_b32 v243, s52
s_mov_b64 exec, 0xff
buffer_store_dwordx4 v[240:243], v248, s[56:59], s27 offen sc1
s_mov_b64 exec, -1
s_branch Lc_end
L_end:
s_endpgm
.section .rodata,"a"
.p2align 6
.amdhsa_kernel standalone__weight_only_int_quip__prompt_kernel
  .amdhsa_next_free_vgpr 256
  .amdhsa_next_free_sgpr 102
  .amdhsa_accum_offset 256
  .amdhsa_group_segment_fixed_size 0
  .amdhsa_kernarg_size 72
  .amdhsa_user_sgpr_count 2
  .amdhsa_user_sgpr_kernarg_segment_ptr 1
  .amdhsa_system_sgpr_workgroup_id_x 1
  .amdhsa_float_denorm_mode_32 3
.end_amdhsa_kernel
```
